```python
import torch

def _softmax(x, axis=-1):
    return torch.softmax(x, dim=axis)
def _gelu(x):
    return torch.nn.functional.gelu(x, approximate="tanh")
def _silu(x):
    return torch.nn.functional.silu(x)
def _sigmoid(x):
    return torch.sigmoid(x)
def _layernorm(x, axis=-1, eps=1e-5):
    m = x.mean(dim=axis, keepdim=True)
    v = x.var(dim=axis, keepdim=True, unbiased=False)
    return (x - m) / torch.sqrt(v + eps)
def _scatter_add(tgt, idx, src, axis=0):
    return tgt.clone().index_add_(axis, idx, src)
def _segment_sum(src, seg, n):
    out = torch.zeros((n,) + src.shape[1:], dtype=src.dtype)
    return out.index_add_(0, seg, src)
def _pad(x, pw):
    flat = tuple(v for pair in reversed(pw) for v in pair)
    return torch.nn.functional.pad(x, flat)

kernel_name = 'sequential_preLN__gqa_block_cached__glu_gated_bilinear__decode'

def setup_inputs():

    _w = (lambda a: (lambda t: t.to(torch.bfloat16) if t.is_floating_point() else t)(torch.as_tensor(a)))
    def _A_setup():
        B, Sq, D = 1, 1, 512
        Hq, Hkv, Sk, Dh = 32, 8, 65536, 128
        assert Hq % Hkv == 0, (Hq, Hkv)
        return {
            "x": _w((lambda *s: torch.randn(*s, dtype=torch.bfloat16) * 0.05)(B, Sq, D)),
            "k_cache": _w((lambda *s: torch.randn(*s, dtype=torch.bfloat16) * 3.2)(B, Hkv, Sk, Dh)),
            "v_cache": _w((lambda *s: torch.randn(*s, dtype=torch.bfloat16) * 1.6)(B, Hkv, Sk, Dh)),
            "wq": _w((lambda *s: torch.randn(*s, dtype=torch.bfloat16) * 3.2)(D, Hq * Dh) * (D ** -0.5)),
            "wo": _w((lambda *s: torch.randn(*s, dtype=torch.bfloat16) * 1.6)(Hq * Dh, D) * ((Hq * Dh) ** -0.5)),
        }
    _A_in = _A_setup()

    def _B_setup():
        B, S, D, F = 1, 1, 512, 1792
        return {
            "x": _w((lambda *s: torch.randn(*s, dtype=torch.bfloat16) * 0.05)(B, S, D)),
            "w_gate": _w((lambda *s: torch.randn(*s, dtype=torch.bfloat16) * 1.6)(D, F) * (D ** -0.5)),
            "w_up": _w((lambda *s: torch.randn(*s, dtype=torch.bfloat16) * 1.6)(D, F) * (D ** -0.5)),
            "w_down": _w((lambda *s: torch.randn(*s, dtype=torch.bfloat16) * 1.6)(F, D) * (F ** -0.5)),
        }
    _B_in = _B_setup()

    return {
        "A_x": _A_in["x"],
        "A_k_cache": _A_in["k_cache"],
        "A_v_cache": _A_in["v_cache"],
        "A_wq": _A_in["wq"],
        "A_wo": _A_in["wo"],
        "B_x": _B_in["x"],
        "B_w_gate": _B_in["w_gate"],
        "B_w_up": _B_in["w_up"],
        "B_w_down": _B_in["w_down"],
    }

def reference(A_x, A_k_cache, A_v_cache, A_wq, A_wo, B_x, B_w_gate, B_w_up, B_w_down):
    def _A_ref(x, k_cache, v_cache, wq, wo):
        B, Sq, D = x.shape
        Hq, Dh = 32, 128
        Hkv = k_cache.shape[1]
        rep = Hq // Hkv
        q = (lambda x, *d: x.permute(*d))((x @ wq).reshape(B, Sq, Hq, Dh), 0, 2, 1, 3)
        k = (lambda x, n, axis: torch.repeat_interleave(x, n, dim=axis))(k_cache, rep, axis=1)
        v = (lambda x, n, axis: torch.repeat_interleave(x, n, dim=axis))(v_cache, rep, axis=1)
        scores = torch.einsum("bhqd,bhkd->bhqk", q, k) * (Dh ** -0.5)
        p = _softmax(scores, axis=-1)
        o = torch.einsum("bhqk,bhkd->bhqd", p, v)
        return (lambda x, *d: x.permute(*d))(o, 0, 2, 1, 3).reshape(B, Sq, Hq * Dh) @ wo

    def _B_ref(x, w_gate, w_up, w_down):
        g = torch.einsum("bsd,df->bsf", x, w_gate)
        u = torch.einsum("bsd,df->bsf", x, w_up)
        h = g * u
        return torch.einsum("bsf,fd->bsd", h, w_down)

    x = A_x
    h = x + _A_ref(_layernorm(x, axis=-1), A_k_cache, A_v_cache, A_wq, A_wo)
    h2 = h + _B_ref(_layernorm(h, axis=-1), B_w_gate, B_w_up, B_w_down)
    return h2
```

```asm
; @launch grid=(256,1,1) block=(512,1,1) lds=98304
.amdgcn_target "amdgcn-amd-amdhsa--gfx950"
.text
.globl sequential_preLN__gqa_block_cached__glu_gated_bilinear__decode_kernel
.p2align 8
.type sequential_preLN__gqa_block_cached__glu_gated_bilinear__decode_kernel,@function
sequential_preLN__gqa_block_cached__glu_gated_bilinear__decode_kernel:
    s_load_dwordx2 s[32:33], s[0:1], 8
    v_cmp_lt_u32 vcc, 0xff, v0
    v_and_b32 v2, 3, v0
    v_lshlrev_b32 v2, 4, v2
    v_and_b32 v5, 48, v0
    v_lshl_or_b32 v2, v5, 2, v2
    s_cbranch_vccnz L_service
    v_and_b32 v5, 0xcc, v0
    v_lshl_or_b32 v2, v5, 6, v2
    s_mul_i32 s48, s2, 0x01010000
    s_and_b32 s48, s48, 0x07e00000
    s_lshr_b32 s6, s48, 4
    s_xor_b32 s48, s48, s6
    s_and_b32 s6, s2, 24
    v_lshl_or_b32 v2, s6, 11, v2
    s_lshl_b32 s34, 1, 27
    s_lshl_b32 s35, 1, 17
    s_waitcnt lgkmcnt(0)
    buffer_load_dwordx4 v[96:99], v2, s[32:35], s48 offen offset:0 nt
    buffer_load_dwordx4 v[100:103], v2, s[32:35], s48 offen offset:1024 nt
    buffer_load_dwordx4 v[104:107], v2, s[32:35], s48 offen offset:2048 nt
    buffer_load_dwordx4 v[108:111], v2, s[32:35], s48 offen offset:3072 nt
    s_branch L_stream
L_service:
    s_cmpk_ge_u32 s2, 256
    s_cbranch_scc1 L_end
    s_load_dwordx16 s[8:23], s[0:1], 0
    s_load_dwordx8 s[24:31], s[0:1], 64
    v_lshrrev_b32 v5, 6, v0
    v_and_b32 v1, 63, v0
    v_readfirstlane_b32 s3, v5
    s_and_b32 s4, s2, 7
    s_lshr_b32 s5, s2, 3
    s_lshl_b32 s49, s4, 5
    s_add_u32 s49, s49, s5
    v_lshlrev_b32 v3, 4, v1
    v_mov_b32 v8, 0
    v_mov_b32 v9, 0
    v_mov_b32 v10, 0
    v_mov_b32 v11, 0
    v_mov_b32 v64, 79072
    s_cmp_eq_u32 s3, 4
    s_cbranch_scc0 L_sv1
    ds_write_b128 v64, v[8:11]
    ds_write_b128 v64, v[8:11] offset:16
    ds_write_b128 v64, v[8:11] offset:32
L_sv1:
    s_getpc_b64 s[6:7]
    v_lshl_add_u32 v6, v5, 11, v3
    v_add_u32 v6, 0xffffe000, v6
    global_load_dwordx4 v[56:59], v6, s[6:7]
    global_load_dwordx4 v[60:63], v6, s[6:7] offset:1024
    s_cmp_ge_u32 s5, 16
    s_cbranch_scc1 L_qprod
    s_mov_b32 s46, 0x05040100
    s_mov_b32 s47, 0x07060302
    s_mov_b32 s64, 0x400000
    s_mov_b32 s61, 0
    s_mov_b32 s62, 0
    s_lshl_b32 s52, s4, 1
    s_add_u32 s52, s52, s3
    s_sub_u32 s52, s52, 6
    s_cmp_lt_u32 s5, 16
    s_cselect_b32 s61, 3, s61
    s_cselect_b32 s62, s52, s62
    s_mul_i32 s52, s4, 7
    s_add_u32 s52, s52, s5
    s_sub_u32 s52, s52, 8
    s_cmp_lt_u32 s5, 15
    s_cselect_b32 s61, 2, s61
    s_cselect_b32 s62, s52, s62
    s_cmp_lt_u32 s5, 8
    s_cselect_b32 s61, 1, s61
    s_cselect_b32 s62, s5, s62
    s_sub_u32 s52, s5, 16
    s_cmp_ge_u32 s5, 24
    s_cselect_b32 s61, 1, s61
    s_cselect_b32 s62, s52, s62
    s_waitcnt lgkmcnt(0)
    s_barrier
    s_cmp_eq_u32 s3, 4
    s_cbranch_scc0 L_sv4
    global_load_dword v10, v9, s[30:31] sc1
    s_waitcnt vmcnt(0)
    v_readfirstlane_b32 s60, v10
    s_nop 0
    s_add_u32 s60, s60, 0x01010101
    s_bfe_u32 s76, s60, 0x80000
    s_bfe_u32 s77, s60, 0x80008
    s_bfe_u32 s78, s60, 0x80010
    s_bfe_u32 s79, s60, 0x80018
    s_branch L_qget
L_qprod:
    s_setprio 3
    s_and_b32 s57, s5, 7
    s_lshl_b32 s63, s4, 3
    s_add_u32 s63, s63, s57
    s_sub_u32 s56, s5, 16
    s_lshr_b32 s56, s56, 3
    s_lshl_b32 s55, s56, 2
    s_add_u32 s55, s55, s3
    s_sub_u32 s55, s55, 4
    s_mul_i32 s55, s55, 64
    v_lshrrev_b32 v5, 3, v1
    v_lshlrev_b32 v6, 2, v5
    s_lshl_b32 s52, s55, 1
    v_add_u32 v6, s52, v6
    v_lshlrev_b32 v7, 14, v5
    v_and_b32 v4, 7, v1
    v_lshl_add_u32 v7, v4, 4, v7
    s_lshl_b32 s52, s55, 13
    s_lshl_b32 s53, s63, 7
    s_add_u32 s52, s52, s53
    v_add_u32 v7, s52, v7
    s_waitcnt lgkmcnt(0)
    global_load_dwordx4 v[66:69], v3, s[8:9]
    global_load_dword v12, v6, s[8:9] offset:0
    global_load_dword v13, v6, s[8:9] offset:32
    global_load_dword v14, v6, s[8:9] offset:64
    global_load_dword v15, v6, s[8:9] offset:96
    global_load_dword v10, v9, s[30:31] sc1
    global_load_dwordx4 v[128:131], v7, s[14:15] nt
    v_add_u32 v7, 8192, v7
    global_load_dwordx4 v[132:135], v7, s[14:15] nt
    v_add_u32 v7, 122880, v7
    global_load_dwordx4 v[136:139], v7, s[14:15] nt
    v_add_u32 v7, 8192, v7
    global_load_dwordx4 v[140:143], v7, s[14:15] nt
    v_add_u32 v7, 122880, v7
    global_load_dwordx4 v[144:147], v7, s[14:15] nt
    v_add_u32 v7, 8192, v7
    global_load_dwordx4 v[148:151], v7, s[14:15] nt
    v_add_u32 v7, 122880, v7
    global_load_dwordx4 v[152:155], v7, s[14:15] nt
    v_add_u32 v7, 8192, v7
    global_load_dwordx4 v[156:159], v7, s[14:15] nt
    s_barrier
    s_mov_b32 s46, 0x05040100
    s_mov_b32 s47, 0x07060302
    s_mov_b32 s64, 0x400000
    s_mov_b32 s61, 0
    s_mov_b32 s62, 0
    s_lshl_b32 s52, s4, 1
    s_add_u32 s52, s52, s3
    s_sub_u32 s52, s52, 6
    s_cmp_lt_u32 s5, 16
    s_cselect_b32 s61, 3, s61
    s_cselect_b32 s62, s52, s62
    s_mul_i32 s52, s4, 7
    s_add_u32 s52, s52, s5
    s_sub_u32 s52, s52, 8
    s_cmp_lt_u32 s5, 15
    s_cselect_b32 s61, 2, s61
    s_cselect_b32 s62, s52, s62
    s_cmp_lt_u32 s5, 8
    s_cselect_b32 s61, 1, s61
    s_cselect_b32 s62, s5, s62
    s_sub_u32 s52, s5, 16
    s_cmp_ge_u32 s5, 24
    s_cselect_b32 s61, 1, s61
    s_cselect_b32 s62, s52, s62
    s_waitcnt vmcnt(13)
    v_lshlrev_b32 v44, 16, v66
    v_and_b32 v45, 0xffff0000, v66
    v_lshlrev_b32 v46, 16, v67
    v_and_b32 v47, 0xffff0000, v67
    v_lshlrev_b32 v48, 16, v68
    v_and_b32 v49, 0xffff0000, v68
    v_lshlrev_b32 v50, 16, v69
    v_and_b32 v51, 0xffff0000, v69
    v_pk_add_f32 v[52:53], v[44:45], v[46:47]
    v_pk_add_f32 v[54:55], v[48:49], v[50:51]
    v_pk_add_f32 v[52:53], v[52:53], v[54:55]
    v_add_f32 v84, v52, v53
    s_nop 1
    v_add_f32_dpp v84, v84, v84 row_ror:8 row_mask:0xf bank_mask:0xf
    s_nop 1
    v_add_f32_dpp v84, v84, v84 row_ror:4 row_mask:0xf bank_mask:0xf
    s_nop 1
    v_add_f32_dpp v84, v84, v84 row_ror:2 row_mask:0xf bank_mask:0xf
    s_nop 1
    v_add_f32_dpp v84, v84, v84 row_ror:1 row_mask:0xf bank_mask:0xf
    v_mov_b32 v85, v84
    s_nop 1
    v_permlane16_swap_b32 v85, v84
    v_add_f32 v84, v85, v84
    v_mov_b32 v85, v84
    s_nop 1
    v_permlane32_swap_b32 v85, v84
    v_add_f32 v84, v85, v84
    v_mul_f32 v84, 0x3b000000, v84
    v_sub_f32 v44, v44, v84
    v_sub_f32 v45, v45, v84
    v_sub_f32 v46, v46, v84
    v_sub_f32 v47, v47, v84
    v_sub_f32 v48, v48, v84
    v_sub_f32 v49, v49, v84
    v_sub_f32 v50, v50, v84
    v_sub_f32 v51, v51, v84
    v_mul_f32 v86, v44, v44
    v_mul_f32 v87, v45, v45
    v_fmac_f32 v86, v46, v46
    v_fmac_f32 v87, v47, v47
    v_fmac_f32 v86, v48, v48
    v_fmac_f32 v87, v49, v49
    v_fmac_f32 v86, v50, v50
    v_fmac_f32 v87, v51, v51
    v_add_f32 v86, v86, v87
    s_nop 1
    v_add_f32_dpp v86, v86, v86 row_ror:8 row_mask:0xf bank_mask:0xf
    s_nop 1
    v_add_f32_dpp v86, v86, v86 row_ror:4 row_mask:0xf bank_mask:0xf
    s_nop 1
    v_add_f32_dpp v86, v86, v86 row_ror:2 row_mask:0xf bank_mask:0xf
    s_nop 1
    v_add_f32_dpp v86, v86, v86 row_ror:1 row_mask:0xf bank_mask:0xf
    v_mov_b32 v85, v86
    s_nop 1
    v_permlane16_swap_b32 v85, v86
    v_add_f32 v86, v85, v86
    v_mov_b32 v85, v86
    s_nop 1
    v_permlane32_swap_b32 v85, v86
    v_add_f32 v86, v85, v86
    v_mul_f32 v86, 0x3b000000, v86
    v_cvt_pk_bf16_f32 v85, v84, v86
    v_lshlrev_b32 v84, 16, v85
    v_and_b32 v86, 0xffff0000, v85
    v_add_f32 v86, 0x3727c5ac, v86
    v_cvt_pk_bf16_f32 v85, v86, v86
    v_lshlrev_b32 v86, 16, v85
    v_sqrt_f32 v86, v86
    s_nop 0
    v_cvt_pk_bf16_f32 v85, v86, v86
    v_lshlrev_b32 v86, 16, v85
    v_rcp_f32 v86, v86
    s_waitcnt vmcnt(9)
    v_lshlrev_b32 v20, 16, v12
    v_and_b32 v21, 0xffff0000, v12
    v_lshlrev_b32 v22, 16, v13
    v_and_b32 v23, 0xffff0000, v13
    v_lshlrev_b32 v24, 16, v14
    v_and_b32 v25, 0xffff0000, v14
    v_lshlrev_b32 v26, 16, v15
    v_and_b32 v27, 0xffff0000, v15
    v_sub_f32 v20, v20, v84
    v_sub_f32 v21, v21, v84
    v_sub_f32 v22, v22, v84
    v_sub_f32 v23, v23, v84
    v_sub_f32 v24, v24, v84
    v_sub_f32 v25, v25, v84
    v_sub_f32 v26, v26, v84
    v_sub_f32 v27, v27, v84
    v_cvt_pk_bf16_f32 v12, v20, v21
    v_cvt_pk_bf16_f32 v13, v22, v23
    v_cvt_pk_bf16_f32 v14, v24, v25
    v_cvt_pk_bf16_f32 v15, v26, v27
    v_lshlrev_b32 v20, 16, v12
    v_and_b32 v21, 0xffff0000, v12
    v_lshlrev_b32 v22, 16, v13
    v_and_b32 v23, 0xffff0000, v13
    v_lshlrev_b32 v24, 16, v14
    v_and_b32 v25, 0xffff0000, v14
    v_lshlrev_b32 v26, 16, v15
    v_and_b32 v27, 0xffff0000, v15
    v_mul_f32 v20, v86, v20
    v_mul_f32 v21, v86, v21
    v_mul_f32 v22, v86, v22
    v_mul_f32 v23, v86, v23
    v_mul_f32 v24, v86, v24
    v_mul_f32 v25, v86, v25
    v_mul_f32 v26, v86, v26
    v_mul_f32 v27, v86, v27
    v_cvt_pk_bf16_f32 v12, v20, v21
    v_cvt_pk_bf16_f32 v13, v22, v23
    v_cvt_pk_bf16_f32 v14, v24, v25
    v_cvt_pk_bf16_f32 v15, v26, v27
    v_mov_b32 v36, 0
    v_mov_b32 v37, 0
    v_mov_b32 v38, 0
    v_mov_b32 v39, 0
    v_mov_b32 v40, 0
    v_mov_b32 v41, 0
    v_mov_b32 v42, 0
    v_mov_b32 v43, 0
    v_lshrrev_b32 v5, 4, v1
    v_lshlrev_b32 v5, 3, v5
    v_lshl_add_u32 v5, v4, 5, v5
    s_lshl_b32 s52, s3, 8
    s_add_u32 s52, s52, 73728
    v_add_u32 v5, s52, v5
    s_waitcnt vmcnt(6)
    v_perm_b32 v44, v132, v128, s46
    v_perm_b32 v45, v132, v128, s47
    v_perm_b32 v46, v133, v129, s46
    v_perm_b32 v47, v133, v129, s47
    v_perm_b32 v48, v134, v130, s46
    v_perm_b32 v49, v134, v130, s47
    v_perm_b32 v50, v135, v131, s46
    v_perm_b32 v51, v135, v131, s47
    v_dot2c_f32_bf16 v36, v44, v12
    v_dot2c_f32_bf16 v37, v45, v12
    v_dot2c_f32_bf16 v38, v46, v12
    v_dot2c_f32_bf16 v39, v47, v12
    v_dot2c_f32_bf16 v40, v48, v12
    v_dot2c_f32_bf16 v41, v49, v12
    v_dot2c_f32_bf16 v42, v50, v12
    v_dot2c_f32_bf16 v43, v51, v12
    s_waitcnt vmcnt(4)
    v_perm_b32 v44, v140, v136, s46
    v_perm_b32 v45, v140, v136, s47
    v_perm_b32 v46, v141, v137, s46
    v_perm_b32 v47, v141, v137, s47
    v_perm_b32 v48, v142, v138, s46
    v_perm_b32 v49, v142, v138, s47
    v_perm_b32 v50, v143, v139, s46
    v_perm_b32 v51, v143, v139, s47
    v_dot2c_f32_bf16 v36, v44, v13
    v_dot2c_f32_bf16 v37, v45, v13
    v_dot2c_f32_bf16 v38, v46, v13
    v_dot2c_f32_bf16 v39, v47, v13
    v_dot2c_f32_bf16 v40, v48, v13
    v_dot2c_f32_bf16 v41, v49, v13
    v_dot2c_f32_bf16 v42, v50, v13
    v_dot2c_f32_bf16 v43, v51, v13
    s_waitcnt vmcnt(2)
    v_perm_b32 v44, v148, v144, s46
    v_perm_b32 v45, v148, v144, s47
    v_perm_b32 v46, v149, v145, s46
    v_perm_b32 v47, v149, v145, s47
    v_perm_b32 v48, v150, v146, s46
    v_perm_b32 v49, v150, v146, s47
    v_perm_b32 v50, v151, v147, s46
    v_perm_b32 v51, v151, v147, s47
    v_dot2c_f32_bf16 v36, v44, v14
    v_dot2c_f32_bf16 v37, v45, v14
    v_dot2c_f32_bf16 v38, v46, v14
    v_dot2c_f32_bf16 v39, v47, v14
    v_dot2c_f32_bf16 v40, v48, v14
    v_dot2c_f32_bf16 v41, v49, v14
    v_dot2c_f32_bf16 v42, v50, v14
    v_dot2c_f32_bf16 v43, v51, v14
    s_waitcnt vmcnt(0)
    v_perm_b32 v44, v156, v152, s46
    v_perm_b32 v45, v156, v152, s47
    v_perm_b32 v46, v157, v153, s46
    v_perm_b32 v47, v157, v153, s47
    v_perm_b32 v48, v158, v154, s46
    v_perm_b32 v49, v158, v154, s47
    v_perm_b32 v50, v159, v155, s46
    v_perm_b32 v51, v159, v155, s47
    v_dot2c_f32_bf16 v36, v44, v15
    v_dot2c_f32_bf16 v37, v45, v15
    v_dot2c_f32_bf16 v38, v46, v15
    v_dot2c_f32_bf16 v39, v47, v15
    v_dot2c_f32_bf16 v40, v48, v15
    v_dot2c_f32_bf16 v41, v49, v15
    v_dot2c_f32_bf16 v42, v50, v15
    v_dot2c_f32_bf16 v43, v51, v15
    v_permlane32_swap_b32 v36, v40
    s_nop 0
    v_permlane32_swap_b32 v38, v42
    v_permlane32_swap_b32 v37, v41
    v_permlane32_swap_b32 v39, v43
    v_add_f32 v36, v36, v40
    v_add_f32 v38, v38, v42
    v_add_f32 v37, v37, v41
    v_add_f32 v39, v39, v43
    v_permlane16_swap_b32 v36, v38
    s_nop 0
    v_permlane16_swap_b32 v37, v39
    v_add_f32 v36, v36, v38
    v_add_f32 v37, v37, v39
    s_nop 0
    v_add_f32_dpp v36, v36, v36 row_ror:8 row_mask:0xf bank_mask:0xf
    v_add_f32_dpp v37, v37, v37 row_ror:8 row_mask:0xf bank_mask:0xf
    ds_write_b64 v5, v[36:37]
    v_mov_b32 v44, 1
    s_mov_b64 exec, 1
    ds_add_u32 v64, v44 offset:32
    s_mov_b64 exec, -1
    s_cmp_eq_u32 s3, 4
    s_cbranch_scc1 L_qp4
    s_setprio 0
    s_branch L_sv4
L_qp4:
    v_readfirstlane_b32 s60, v10
    s_nop 0
    s_add_u32 s60, s60, 0x01010101
    s_bfe_u32 s76, s60, 0x80000
    s_bfe_u32 s77, s60, 0x80008
    s_bfe_u32 s78, s60, 0x80010
    s_bfe_u32 s79, s60, 0x80018
    s_mul_i32 s53, s4, 2
    s_add_u32 s53, s53, s56
    s_lshl_b32 s53, s53, 3
    s_add_u32 s53, s53, s57
    s_lshl_b32 s53, s53, 9
    s_add_u32 s53, s53, 917504
    v_add_u32 v6, s53, v3
    v_lshlrev_b32 v5, 3, v1
    v_add_u32 v5, 74752, v5
    v_mov_b32 v84, 79104
L_qpw:
    ds_read_b32 v85, v84
    s_sub_u32 s64, s64, 1
    s_cbranch_scc1 L_end
    s_waitcnt lgkmcnt(0)
    v_readfirstlane_b32 s52, v85
    s_nop 0
    s_cmp_ge_u32 s52, 4
    s_cbranch_scc1 L_qpw_go
    s_sleep 0
    s_branch L_qpw
L_qpw_go:
    s_mov_b32 exec_hi, 0
    ds_read_b64 v[48:49], v5 offset:0
    ds_read_b64 v[50:51], v5 offset:256
    ds_read_b64 v[52:53], v5 offset:512
    ds_read_b64 v[54:55], v5 offset:768
    s_waitcnt lgkmcnt(0)
    v_pk_add_f32 v[48:49], v[48:49], v[50:51]
    v_pk_add_f32 v[52:53], v[52:53], v[54:55]
    v_add_f32 v44, v48, v52
    v_add_f32 v46, v49, v53
    v_mov_b32 v45, s60
    v_mov_b32 v47, s60
    global_store_dwordx4 v6, v[44:47], s[30:31] sc1
    s_mov_b64 exec, -1
    s_setprio 0
L_qget:
    s_mul_i32 s52, s4, 8192
    s_add_u32 s52, s52, 921600
    v_add_u32 v5, s52, v3
    v_add_u32 v7, 0x2000, v5
    v_lshlrev_b32 v6, 2, v1
    v_add_u32 v6, 65536, v6
    v_mov_b32 v52, s60
    ds_write_b32 v64, v52 offset:16
    v_mov_b32 v84, 79108
L_qs:
    ds_read_b32 v85, v84
    s_sub_u32 s64, s64, 1
    s_cbranch_scc1 L_end
    s_waitcnt lgkmcnt(0)
    v_readfirstlane_b32 s52, v85
    s_nop 0
    s_cmp_ge_u32 s52, 1
    s_cbranch_scc1 L_qs_go
    s_sleep 4
    s_branch L_qs
L_qs_go:
    s_mov_b32 s57, 0
L_qpoll:
    s_sub_u32 s64, s64, 1
    s_cbranch_scc1 L_end
    s_bitcmp1_b32 s57, 0
    s_cbranch_scc1 L_qk0
    global_load_dwordx4 v[128:131], v5, s[30:31] offset:-4096 sc1
L_qk0:
    s_bitcmp1_b32 s57, 1
    s_cbranch_scc1 L_qk1
    global_load_dwordx4 v[132:135], v5, s[30:31] offset:-3072 sc1
L_qk1:
    s_bitcmp1_b32 s57, 2
    s_cbranch_scc1 L_qk2
    global_load_dwordx4 v[136:139], v5, s[30:31] offset:-2048 sc1
L_qk2:
    s_bitcmp1_b32 s57, 3
    s_cbranch_scc1 L_qk3
    global_load_dwordx4 v[140:143], v5, s[30:31] offset:-1024 sc1
L_qk3:
    s_bitcmp1_b32 s57, 4
    s_cbranch_scc1 L_qk4
    global_load_dwordx4 v[144:147], v5, s[30:31] offset:0 sc1
L_qk4:
    s_bitcmp1_b32 s57, 5
    s_cbranch_scc1 L_qk5
    global_load_dwordx4 v[148:151], v5, s[30:31] offset:1024 sc1
L_qk5:
    s_bitcmp1_b32 s57, 6
    s_cbranch_scc1 L_qk6
    global_load_dwordx4 v[152:155], v5, s[30:31] offset:2048 sc1
L_qk6:
    s_bitcmp1_b32 s57, 7
    s_cbranch_scc1 L_qk7
    global_load_dwordx4 v[156:159], v5, s[30:31] offset:3072 sc1
L_qk7:
    s_waitcnt vmcnt(0)
    s_mov_b32 s57, 0
    v_xor_b32 v84, s60, v129
    v_bitop3_b32 v84, v84, v131, s60 bitop3:0xf6
    v_cmp_ne_u32 vcc, 0, v84
    s_nop 0
    s_cmp_eq_u64 vcc, 0
    s_cselect_b32 s52, 1, 0
    s_or_b32 s57, s57, s52
    v_xor_b32 v84, s60, v133
    v_bitop3_b32 v84, v84, v135, s60 bitop3:0xf6
    v_cmp_ne_u32 vcc, 0, v84
    s_nop 0
    s_cmp_eq_u64 vcc, 0
    s_cselect_b32 s52, 2, 0
    s_or_b32 s57, s57, s52
    v_xor_b32 v84, s60, v137
    v_bitop3_b32 v84, v84, v139, s60 bitop3:0xf6
    v_cmp_ne_u32 vcc, 0, v84
    s_nop 0
    s_cmp_eq_u64 vcc, 0
    s_cselect_b32 s52, 4, 0
    s_or_b32 s57, s57, s52
    v_xor_b32 v84, s60, v141
    v_bitop3_b32 v84, v84, v143, s60 bitop3:0xf6
    v_cmp_ne_u32 vcc, 0, v84
    s_nop 0
    s_cmp_eq_u64 vcc, 0
    s_cselect_b32 s52, 8, 0
    s_or_b32 s57, s57, s52
    v_xor_b32 v84, s60, v145
    v_bitop3_b32 v84, v84, v147, s60 bitop3:0xf6
    v_cmp_ne_u32 vcc, 0, v84
    s_nop 0
    s_cmp_eq_u64 vcc, 0
    s_cselect_b32 s52, 16, 0
    s_or_b32 s57, s57, s52
    v_xor_b32 v84, s60, v149
    v_bitop3_b32 v84, v84, v151, s60 bitop3:0xf6
    v_cmp_ne_u32 vcc, 0, v84
    s_nop 0
    s_cmp_eq_u64 vcc, 0
    s_cselect_b32 s52, 32, 0
    s_or_b32 s57, s57, s52
    v_xor_b32 v84, s60, v153
    v_bitop3_b32 v84, v84, v155, s60 bitop3:0xf6
    v_cmp_ne_u32 vcc, 0, v84
    s_nop 0
    s_cmp_eq_u64 vcc, 0
    s_cselect_b32 s52, 64, 0
    s_or_b32 s57, s57, s52
    v_xor_b32 v84, s60, v157
    v_bitop3_b32 v84, v84, v159, s60 bitop3:0xf6
    v_cmp_ne_u32 vcc, 0, v84
    s_nop 0
    s_cmp_eq_u64 vcc, 0
    s_cselect_b32 s52, 128, 0
    s_or_b32 s57, s57, s52
    s_cmp_eq_u32 s57, 255
    s_cbranch_scc1 L_qgot
    s_sleep 8
    s_branch L_qpoll
L_qgot:
    v_add_f32 v128, v128, v144
    v_add_f32 v130, v130, v146
    v_cvt_pk_bf16_f32 v128, v128, v130
    ds_write_b32 v6, v128 offset:0
    v_add_f32 v132, v132, v148
    v_add_f32 v134, v134, v150
    v_cvt_pk_bf16_f32 v132, v132, v134
    ds_write_b32 v6, v132 offset:256
    v_add_f32 v136, v136, v152
    v_add_f32 v138, v138, v154
    v_cvt_pk_bf16_f32 v136, v136, v138
    ds_write_b32 v6, v136 offset:512
    v_add_f32 v140, v140, v156
    v_add_f32 v142, v142, v158
    v_cvt_pk_bf16_f32 v140, v140, v142
    ds_write_b32 v6, v140 offset:768
    v_mov_b32 v48, 1
    ds_write_b32 v64, v48
    s_branch L_down
L_stream:
    s_cmpk_ge_u32 s2, 256
    s_cbranch_scc1 L_end
    s_and_b32 s7, s48, 0x07e00000
    s_and_b32 s48, s48, 0x1fffff
    v_add_u32 v2, s7, v2
    v_add_u32 v90, 0x10000, v2
    buffer_load_dwordx4 v[112:115], v90, s[32:35], s48 offen offset:0 nt
    s_load_dwordx16 s[8:23], s[0:1], 0
    s_load_dwordx8 s[24:31], s[0:1], 64
    v_lshrrev_b32 v5, 6, v0
    v_and_b32 v1, 63, v0
    v_readfirstlane_b32 s3, v5
    s_and_b32 s4, s2, 7
    s_lshr_b32 s5, s2, 3
    s_lshl_b32 s49, s4, 5
    s_add_u32 s49, s49, s5
    v_lshlrev_b32 v3, 4, v1
    s_mov_b32 s46, 0x05040100
    s_mov_b32 s47, 0x07060302
    s_mov_b32 s64, 0x400000
    s_mov_b32 s61, 0
    s_mov_b32 s62, 0
    s_lshl_b32 s52, s4, 1
    s_add_u32 s52, s52, s3
    s_sub_u32 s52, s52, 6
    s_cmp_lt_u32 s5, 16
    s_cselect_b32 s61, 3, s61
    s_cselect_b32 s62, s52, s62
    s_mul_i32 s52, s4, 7
    s_add_u32 s52, s52, s5
    s_sub_u32 s52, s52, 8
    s_cmp_lt_u32 s5, 15
    s_cselect_b32 s61, 2, s61
    s_cselect_b32 s62, s52, s62
    s_cmp_lt_u32 s5, 8
    s_cselect_b32 s61, 1, s61
    s_cselect_b32 s62, s5, s62
    s_sub_u32 s52, s5, 16
    s_cmp_ge_u32 s5, 24
    s_cselect_b32 s61, 1, s61
    s_cselect_b32 s62, s52, s62
    v_and_b32 v0, 0xfffff000, v2
    v_add_u32 v0, v0, v3
    v_add_u32 v91, 0x10000, v0
    s_mov_b32 s38, 134217728
    s_mov_b32 s39, 0x20000
    s_xor_b32 s6, s3, 0
    s_lshl_b32 s6, s6, 10
    s_xor_b32 s7, s3, 1
    s_lshl_b32 s7, s7, 10
    s_xor_b32 s50, s3, 2
    s_lshl_b32 s50, s50, 10
    s_xor_b32 s63, s3, 3
    s_lshl_b32 s63, s63, 10
    s_mov_b32 s44, 0x3db504f3
    s_mov_b32 s45, 0x3fb8aa3b
    v_and_b32 v88, 3, v1
    v_lshlrev_b32 v88, 3, v88
    s_lshl_b32 s52, s3, 5
    s_add_u32 s52, s52, 78912
    v_add_u32 v88, s52, v88
    v_and_b32 v84, 3, v1
    v_lshlrev_b32 v84, 8, v84
    v_lshrrev_b32 v85, 4, v1
    v_lshlrev_b32 v85, 6, v85
    s_mov_b32 s52, 65536
    v_add3_u32 v84, v84, v85, s52
    v_bfe_u32 v85, v1, 2, 2
    v_subrev_u32 v86, 0, v85
    v_and_b32 v86, 3, v86
    v_lshl_add_u32 v44, v86, 4, v84
    v_subrev_u32 v86, 1, v85
    v_and_b32 v86, 3, v86
    v_lshl_add_u32 v45, v86, 4, v84
    v_subrev_u32 v86, 2, v85
    v_and_b32 v86, 3, v86
    v_lshl_add_u32 v46, v86, 4, v84
    v_subrev_u32 v86, 3, v85
    v_and_b32 v86, 3, v86
    v_lshl_add_u32 v47, v86, 4, v84
    s_lshl_b32 s52, s3, 11
    s_add_u32 s52, s52, 66560
    v_add_u32 v92, s52, v3
    s_mov_b32 s51, 0
    s_cmp_eq_u32 s61, 1
    s_cselect_b32 s51, 272, s51
    s_cmp_eq_u32 s61, 2
    s_cselect_b32 s51, 146, s51
    s_cmp_eq_u32 s61, 3
    s_cselect_b32 s51, 0, s51
    s_cmp_ge_u32 s5, 16
    s_cselect_b32 s52, 72, 0
    s_or_b32 s51, s51, s52
    s_waitcnt lgkmcnt(0)
    s_mov_b32 s36, s12
    s_mov_b32 s37, s13
    v_mov_b32 v94, 79072
    v_cmp_eq_u32 vcc, 0, v1
    s_nop 1
    v_cndmask_b32 v95, 0, 1, vcc
    v_mov_b32 v80, 0
    v_mov_b32 v81, 0
    s_barrier
    s_waitcnt vmcnt(4)
    buffer_load_dwordx4 v[116:119], v90, s[32:35], s48 offen offset:1024 nt
    s_waitcnt vmcnt(4)
    buffer_load_dwordx4 v[120:123], v90, s[32:35], s48 offen offset:2048 nt
    s_waitcnt vmcnt(4)
    buffer_load_dwordx4 v[124:127], v90, s[32:35], s48 offen offset:3072 nt
    s_add_u32 s48, s48, 0x20000
    s_bitset0_b32 s48, 21
    s_bitcmp1_b32 s51, 1
    s_cselect_b32 s65, 2, 1
    s_waitcnt vmcnt(6)
    s_cmp_eq_u32 s65, 2
    s_cbranch_scc1 L_go8
    s_waitcnt vmcnt(4)
    s_cmp_eq_u32 s65, 1
    s_cbranch_scc1 L_go8
    s_waitcnt vmcnt(3)
L_go8:
    buffer_load_dwordx4 v[128:131], v2, s[32:35], s48 offen offset:0 nt
    s_waitcnt vmcnt(6)
    s_cmp_eq_u32 s65, 2
    s_cbranch_scc1 L_go9
    s_waitcnt vmcnt(4)
    s_cmp_eq_u32 s65, 1
    s_cbranch_scc1 L_go9
    s_waitcnt vmcnt(3)
L_go9:
    buffer_load_dwordx4 v[132:135], v2, s[32:35], s48 offen offset:1024 nt
    s_waitcnt vmcnt(6)
    s_cmp_eq_u32 s65, 2
    s_cbranch_scc1 L_go10
    s_waitcnt vmcnt(4)
    s_cmp_eq_u32 s65, 1
    s_cbranch_scc1 L_go10
    s_waitcnt vmcnt(3)
L_go10:
    buffer_load_dwordx4 v[136:139], v2, s[32:35], s48 offen offset:2048 nt
    s_waitcnt vmcnt(6)
    s_cmp_eq_u32 s65, 2
    s_cbranch_scc1 L_go11
    s_waitcnt vmcnt(4)
    s_cmp_eq_u32 s65, 1
    s_cbranch_scc1 L_go11
    s_waitcnt vmcnt(3)
L_go11:
    buffer_load_dwordx4 v[140:143], v2, s[32:35], s48 offen offset:3072 nt
    s_waitcnt vmcnt(6)
    s_cmp_eq_u32 s65, 2
    s_cbranch_scc1 L_go12
    s_waitcnt vmcnt(4)
    s_cmp_eq_u32 s65, 1
    s_cbranch_scc1 L_go12
    s_waitcnt vmcnt(3)
L_go12:
    buffer_load_dwordx4 v[144:147], v90, s[32:35], s48 offen offset:0 nt
    s_waitcnt vmcnt(6)
    s_cmp_eq_u32 s65, 2
    s_cbranch_scc1 L_go13
    s_waitcnt vmcnt(4)
    s_cmp_eq_u32 s65, 1
    s_cbranch_scc1 L_go13
    s_waitcnt vmcnt(3)
L_go13:
    buffer_load_dwordx4 v[148:151], v90, s[32:35], s48 offen offset:1024 nt
    s_waitcnt vmcnt(6)
    s_cmp_eq_u32 s65, 2
    s_cbranch_scc1 L_go14
    s_waitcnt vmcnt(4)
    s_cmp_eq_u32 s65, 1
    s_cbranch_scc1 L_go14
    s_waitcnt vmcnt(3)
L_go14:
    buffer_load_dwordx4 v[152:155], v90, s[32:35], s48 offen offset:2048 nt
    s_waitcnt vmcnt(6)
    s_cmp_eq_u32 s65, 2
    s_cbranch_scc1 L_go15
    s_waitcnt vmcnt(4)
    s_cmp_eq_u32 s65, 1
    s_cbranch_scc1 L_go15
    s_waitcnt vmcnt(3)
L_go15:
    buffer_load_dwordx4 v[156:159], v90, s[32:35], s48 offen offset:3072 nt
    s_add_u32 s48, s48, 0x20000
    s_bitset0_b32 s48, 21
    s_bitcmp1_b32 s51, 2
    s_cselect_b32 s65, 2, 1
    s_waitcnt vmcnt(6)
    s_cmp_eq_u32 s65, 2
    s_cbranch_scc1 L_go16
    s_waitcnt vmcnt(4)
    s_cmp_eq_u32 s65, 1
    s_cbranch_scc1 L_go16
    s_waitcnt vmcnt(3)
L_go16:
    buffer_load_dwordx4 v[160:163], v2, s[32:35], s48 offen offset:0 nt
    s_waitcnt vmcnt(6)
    s_cmp_eq_u32 s65, 2
    s_cbranch_scc1 L_go17
    s_waitcnt vmcnt(4)
    s_cmp_eq_u32 s65, 1
    s_cbranch_scc1 L_go17
    s_waitcnt vmcnt(3)
L_go17:
    buffer_load_dwordx4 v[164:167], v2, s[32:35], s48 offen offset:1024 nt
    s_waitcnt vmcnt(6)
    s_cmp_eq_u32 s65, 2
    s_cbranch_scc1 L_go18
    s_waitcnt vmcnt(4)
    s_cmp_eq_u32 s65, 1
    s_cbranch_scc1 L_go18
    s_waitcnt vmcnt(3)
L_go18:
    buffer_load_dwordx4 v[168:171], v2, s[32:35], s48 offen offset:2048 nt
    s_waitcnt vmcnt(6)
    s_cmp_eq_u32 s65, 2
    s_cbranch_scc1 L_go19
    s_waitcnt vmcnt(4)
    s_cmp_eq_u32 s65, 1
    s_cbranch_scc1 L_go19
    s_waitcnt vmcnt(3)
L_go19:
    buffer_load_dwordx4 v[172:175], v2, s[32:35], s48 offen offset:3072 nt
    s_waitcnt vmcnt(6)
    s_cmp_eq_u32 s65, 2
    s_cbranch_scc1 L_go20
    s_waitcnt vmcnt(4)
    s_cmp_eq_u32 s65, 1
    s_cbranch_scc1 L_go20
    s_waitcnt vmcnt(3)
L_go20:
    buffer_load_dwordx4 v[176:179], v90, s[32:35], s48 offen offset:0 nt
    s_waitcnt vmcnt(6)
    s_cmp_eq_u32 s65, 2
    s_cbranch_scc1 L_go21
    s_waitcnt vmcnt(4)
    s_cmp_eq_u32 s65, 1
    s_cbranch_scc1 L_go21
    s_waitcnt vmcnt(3)
L_go21:
    buffer_load_dwordx4 v[180:183], v90, s[32:35], s48 offen offset:1024 nt
    s_waitcnt vmcnt(6)
    s_cmp_eq_u32 s65, 2
    s_cbranch_scc1 L_go22
    s_waitcnt vmcnt(4)
    s_cmp_eq_u32 s65, 1
    s_cbranch_scc1 L_go22
    s_waitcnt vmcnt(3)
L_go22:
    buffer_load_dwordx4 v[184:187], v90, s[32:35], s48 offen offset:2048 nt
    s_waitcnt vmcnt(6)
    s_cmp_eq_u32 s65, 2
    s_cbranch_scc1 L_go23
    s_waitcnt vmcnt(4)
    s_cmp_eq_u32 s65, 1
    s_cbranch_scc1 L_go23
    s_waitcnt vmcnt(3)
L_go23:
    buffer_load_dwordx4 v[188:191], v90, s[32:35], s48 offen offset:3072 nt
    s_add_u32 s48, s48, 0x20000
    s_bitset0_b32 s48, 21
    s_bitcmp1_b32 s51, 3
    s_cselect_b32 s65, 2, 1
    s_waitcnt vmcnt(6)
    s_cmp_eq_u32 s65, 2
    s_cbranch_scc1 L_go24
    s_waitcnt vmcnt(4)
    s_cmp_eq_u32 s65, 1
    s_cbranch_scc1 L_go24
    s_waitcnt vmcnt(3)
L_go24:
    buffer_load_dwordx4 v[192:195], v2, s[32:35], s48 offen offset:0 nt
    ds_add_u32 v94, v95 offset:36
    s_waitcnt vmcnt(6)
    s_cmp_eq_u32 s65, 2
    s_cbranch_scc1 L_go25
    s_waitcnt vmcnt(4)
    s_cmp_eq_u32 s65, 1
    s_cbranch_scc1 L_go25
    s_waitcnt vmcnt(3)
L_go25:
    buffer_load_dwordx4 v[196:199], v2, s[32:35], s48 offen offset:1024 nt
    s_waitcnt vmcnt(6)
    s_cmp_eq_u32 s65, 2
    s_cbranch_scc1 L_go26
    s_waitcnt vmcnt(4)
    s_cmp_eq_u32 s65, 1
    s_cbranch_scc1 L_go26
    s_waitcnt vmcnt(3)
L_go26:
    buffer_load_dwordx4 v[200:203], v2, s[32:35], s48 offen offset:2048 nt
    s_waitcnt vmcnt(6)
    s_cmp_eq_u32 s65, 2
    s_cbranch_scc1 L_go27
    s_waitcnt vmcnt(4)
    s_cmp_eq_u32 s65, 1
    s_cbranch_scc1 L_go27
    s_waitcnt vmcnt(3)
L_go27:
    buffer_load_dwordx4 v[204:207], v2, s[32:35], s48 offen offset:3072 nt
    s_waitcnt vmcnt(6)
    s_cmp_eq_u32 s65, 2
    s_cbranch_scc1 L_go28
    s_waitcnt vmcnt(4)
    s_cmp_eq_u32 s65, 1
    s_cbranch_scc1 L_go28
    s_waitcnt vmcnt(3)
L_go28:
    buffer_load_dwordx4 v[208:211], v90, s[32:35], s48 offen offset:0 nt
    s_waitcnt vmcnt(6)
    s_cmp_eq_u32 s65, 2
    s_cbranch_scc1 L_go29
    s_waitcnt vmcnt(4)
    s_cmp_eq_u32 s65, 1
    s_cbranch_scc1 L_go29
    s_waitcnt vmcnt(3)
L_go29:
    buffer_load_dwordx4 v[212:215], v90, s[32:35], s48 offen offset:1024 nt
    s_waitcnt vmcnt(6)
    s_cmp_eq_u32 s65, 2
    s_cbranch_scc1 L_go30
    s_waitcnt vmcnt(4)
    s_cmp_eq_u32 s65, 1
    s_cbranch_scc1 L_go30
    s_waitcnt vmcnt(3)
L_go30:
    buffer_load_dwordx4 v[216:219], v90, s[32:35], s48 offen offset:2048 nt
    s_waitcnt vmcnt(6)
    s_cmp_eq_u32 s65, 2
    s_cbranch_scc1 L_go31
    s_waitcnt vmcnt(4)
    s_cmp_eq_u32 s65, 1
    s_cbranch_scc1 L_go31
    s_waitcnt vmcnt(3)
L_go31:
    buffer_load_dwordx4 v[220:223], v90, s[32:35], s48 offen offset:3072 nt
    s_add_u32 s48, s48, 0x20000
    s_bitset0_b32 s48, 21
    s_bitcmp1_b32 s51, 4
    s_cselect_b32 s65, 2, 1
    s_waitcnt vmcnt(6)
    s_cmp_eq_u32 s65, 2
    s_cbranch_scc1 L_go32
    s_waitcnt vmcnt(4)
    s_cmp_eq_u32 s65, 1
    s_cbranch_scc1 L_go32
    s_waitcnt vmcnt(3)
L_go32:
    buffer_load_dwordx4 v[224:227], v2, s[32:35], s48 offen offset:0 nt
    s_waitcnt vmcnt(6)
    s_cmp_eq_u32 s65, 2
    s_cbranch_scc1 L_go33
    s_waitcnt vmcnt(4)
    s_cmp_eq_u32 s65, 1
    s_cbranch_scc1 L_go33
    s_waitcnt vmcnt(3)
L_go33:
    buffer_load_dwordx4 v[228:231], v2, s[32:35], s48 offen offset:1024 nt
    s_waitcnt vmcnt(6)
    s_cmp_eq_u32 s65, 2
    s_cbranch_scc1 L_go34
    s_waitcnt vmcnt(4)
    s_cmp_eq_u32 s65, 1
    s_cbranch_scc1 L_go34
    s_waitcnt vmcnt(3)
L_go34:
    buffer_load_dwordx4 v[232:235], v2, s[32:35], s48 offen offset:2048 nt
    s_waitcnt vmcnt(6)
    s_cmp_eq_u32 s65, 2
    s_cbranch_scc1 L_go35
    s_waitcnt vmcnt(4)
    s_cmp_eq_u32 s65, 1
    s_cbranch_scc1 L_go35
    s_waitcnt vmcnt(3)
L_go35:
    buffer_load_dwordx4 v[236:239], v2, s[32:35], s48 offen offset:3072 nt
    s_waitcnt vmcnt(6)
    s_cmp_eq_u32 s65, 2
    s_cbranch_scc1 L_go36
    s_waitcnt vmcnt(4)
    s_cmp_eq_u32 s65, 1
    s_cbranch_scc1 L_go36
    s_waitcnt vmcnt(3)
L_go36:
    buffer_load_dwordx4 v[240:243], v90, s[32:35], s48 offen offset:0 nt
    s_waitcnt vmcnt(6)
    s_cmp_eq_u32 s65, 2
    s_cbranch_scc1 L_go37
    s_waitcnt vmcnt(4)
    s_cmp_eq_u32 s65, 1
    s_cbranch_scc1 L_go37
    s_waitcnt vmcnt(3)
L_go37:
    buffer_load_dwordx4 v[244:247], v90, s[32:35], s48 offen offset:1024 nt
    s_waitcnt vmcnt(6)
    s_cmp_eq_u32 s65, 2
    s_cbranch_scc1 L_go38
    s_waitcnt vmcnt(4)
    s_cmp_eq_u32 s65, 1
    s_cbranch_scc1 L_go38
    s_waitcnt vmcnt(3)
L_go38:
    buffer_load_dwordx4 v[248:251], v90, s[32:35], s48 offen offset:2048 nt
    s_waitcnt vmcnt(6)
    s_cmp_eq_u32 s65, 2
    s_cbranch_scc1 L_go39
    s_waitcnt vmcnt(4)
    s_cmp_eq_u32 s65, 1
    s_cbranch_scc1 L_go39
    s_waitcnt vmcnt(3)
L_go39:
    buffer_load_dwordx4 v[252:255], v90, s[32:35], s48 offen offset:3072 nt
    s_add_u32 s48, s48, 0x20000
    s_bitset0_b32 s48, 21
    s_bitcmp1_b32 s51, 5
    s_cselect_b32 s65, 2, 1
    v_mov_b32 v84, 79072
L_qw:
    ds_read_b32 v85, v84
    s_sub_u32 s64, s64, 1
    s_cbranch_scc1 L_end
    s_waitcnt lgkmcnt(0)
    v_readfirstlane_b32 s52, v85
    s_nop 0
    s_cmp_ge_u32 s52, 1
    s_cbranch_scc1 L_qw_go
    s_sleep 1
    s_branch L_qw
L_qw_go:
    ds_read_b128 v[12:15], v44
    ds_read_b128 v[16:19], v45
    ds_read_b128 v[20:23], v46
    ds_read_b128 v[24:27], v47
    s_waitcnt lgkmcnt(0)
    v_mfma_f32_16x16x32_bf16 v[44:47], v[96:99], v[12:15], 0
    s_waitcnt vmcnt(6)
    s_cmp_eq_u32 s65, 2
    s_cbranch_scc1 L_go40
    s_waitcnt vmcnt(4)
    s_cmp_eq_u32 s65, 1
    s_cbranch_scc1 L_go40
    s_waitcnt vmcnt(3)
L_go40:
    buffer_load_dwordx4 v[96:99], v2, s[32:35], s48 offen offset:0 nt
    v_mfma_f32_16x16x32_bf16 v[48:51], v[100:103], v[16:19], 0
    v_mfma_f32_16x16x32_bf16 v[52:55], v[104:107], v[20:23], 0
    v_mfma_f32_16x16x32_bf16 v[56:59], v[108:111], v[24:27], 0
    v_mfma_f32_16x16x32_bf16 v[60:63], v[112:115], v[12:15], 0
    v_mfma_f32_16x16x32_bf16 v[64:67], v[116:119], v[16:19], 0
    v_mfma_f32_16x16x32_bf16 v[68:71], v[120:123], v[20:23], 0
    v_mfma_f32_16x16x32_bf16 v[72:75], v[124:127], v[24:27], 0
    v_add_f32_dpp v78, v47, v45 row_ror:8 row_mask:0xf bank_mask:0x2
    v_add_f32_dpp v76, v46, v44 row_ror:8 row_mask:0xf bank_mask:0x1
    v_add_f32_dpp v78, v51, v49 row_ror:8 row_mask:0xf bank_mask:0x4
    v_add_f32_dpp v76, v50, v48 row_ror:8 row_mask:0xf bank_mask:0x2
    v_add_f32_dpp v78, v55, v53 row_ror:8 row_mask:0xf bank_mask:0x8
    v_add_f32_dpp v76, v54, v52 row_ror:8 row_mask:0xf bank_mask:0x4
    v_add_f32_dpp v78, v59, v57 row_ror:8 row_mask:0xf bank_mask:0x1
    v_add_f32_dpp v76, v58, v56 row_ror:8 row_mask:0xf bank_mask:0x8
    s_waitcnt vmcnt(6)
    s_cmp_eq_u32 s65, 2
    s_cbranch_scc1 L_go41
    s_waitcnt vmcnt(4)
    s_cmp_eq_u32 s65, 1
    s_cbranch_scc1 L_go41
    s_waitcnt vmcnt(3)
L_go41:
    buffer_load_dwordx4 v[100:103], v2, s[32:35], s48 offen offset:1024 nt
    v_add_f32_dpp v79, v63, v61 row_ror:8 row_mask:0xf bank_mask:0x2
    v_add_f32_dpp v77, v62, v60 row_ror:8 row_mask:0xf bank_mask:0x1
    v_add_f32_dpp v79, v67, v65 row_ror:8 row_mask:0xf bank_mask:0x4
    v_add_f32_dpp v77, v66, v64 row_ror:8 row_mask:0xf bank_mask:0x2
    v_add_f32_dpp v79, v71, v69 row_ror:8 row_mask:0xf bank_mask:0x8
    v_add_f32_dpp v77, v70, v68 row_ror:8 row_mask:0xf bank_mask:0x4
    v_add_f32_dpp v79, v75, v73 row_ror:8 row_mask:0xf bank_mask:0x1
    v_add_f32_dpp v77, v74, v72 row_ror:8 row_mask:0xf bank_mask:0x8
    s_waitcnt vmcnt(6)
    s_cmp_eq_u32 s65, 2
    s_cbranch_scc1 L_go42
    s_waitcnt vmcnt(4)
    s_cmp_eq_u32 s65, 1
    s_cbranch_scc1 L_go42
    s_waitcnt vmcnt(3)
L_go42:
    buffer_load_dwordx4 v[104:107], v2, s[32:35], s48 offen offset:2048 nt
    v_add_f32_dpp v76, v78, v76 row_ror:12 row_mask:0xf bank_mask:0xf
    v_add_f32_dpp v77, v79, v77 row_ror:12 row_mask:0xf bank_mask:0xf
    v_cvt_pk_bf16_f32 v78, v76, v77
    v_lshlrev_b32 v76, 16, v78
    v_and_b32 v77, 0xffff0000, v78
    v_mul_f32 v76, s44, v76
    v_mul_f32 v77, s44, v77
    v_cvt_pk_bf16_f32 v28, v76, v77
    v_lshlrev_b32 v76, 16, v28
    v_and_b32 v77, 0xffff0000, v28
    v_max_f32 v82, v76, v77
    v_mfma_f32_16x16x32_bf16 v[44:47], v[128:131], v[12:15], 0
    v_mfma_f32_16x16x32_bf16 v[48:51], v[132:135], v[16:19], 0
    v_mfma_f32_16x16x32_bf16 v[52:55], v[136:139], v[20:23], 0
    v_mfma_f32_16x16x32_bf16 v[56:59], v[140:143], v[24:27], 0
    v_mfma_f32_16x16x32_bf16 v[60:63], v[144:147], v[12:15], 0
    v_mfma_f32_16x16x32_bf16 v[64:67], v[148:151], v[16:19], 0
    v_mfma_f32_16x16x32_bf16 v[68:71], v[152:155], v[20:23], 0
    s_waitcnt vmcnt(6)
    s_cmp_eq_u32 s65, 2
    s_cbranch_scc1 L_go43
    s_waitcnt vmcnt(4)
    s_cmp_eq_u32 s65, 1
    s_cbranch_scc1 L_go43
    s_waitcnt vmcnt(3)
L_go43:
    buffer_load_dwordx4 v[108:111], v2, s[32:35], s48 offen offset:3072 nt
    v_mfma_f32_16x16x32_bf16 v[72:75], v[156:159], v[24:27], 0
    v_add_f32_dpp v78, v47, v45 row_ror:8 row_mask:0xf bank_mask:0x2
    v_add_f32_dpp v76, v46, v44 row_ror:8 row_mask:0xf bank_mask:0x1
    v_add_f32_dpp v78, v51, v49 row_ror:8 row_mask:0xf bank_mask:0x4
    v_add_f32_dpp v76, v50, v48 row_ror:8 row_mask:0xf bank_mask:0x2
    v_add_f32_dpp v78, v55, v53 row_ror:8 row_mask:0xf bank_mask:0x8
    v_add_f32_dpp v76, v54, v52 row_ror:8 row_mask:0xf bank_mask:0x4
    v_add_f32_dpp v78, v59, v57 row_ror:8 row_mask:0xf bank_mask:0x1
    v_add_f32_dpp v76, v58, v56 row_ror:8 row_mask:0xf bank_mask:0x8
    v_add_f32_dpp v79, v63, v61 row_ror:8 row_mask:0xf bank_mask:0x2
    v_add_f32_dpp v77, v62, v60 row_ror:8 row_mask:0xf bank_mask:0x1
    v_add_f32_dpp v79, v67, v65 row_ror:8 row_mask:0xf bank_mask:0x4
    v_add_f32_dpp v77, v66, v64 row_ror:8 row_mask:0xf bank_mask:0x2
    v_add_f32_dpp v79, v71, v69 row_ror:8 row_mask:0xf bank_mask:0x8
    v_add_f32_dpp v77, v70, v68 row_ror:8 row_mask:0xf bank_mask:0x4
    v_add_f32_dpp v79, v75, v73 row_ror:8 row_mask:0xf bank_mask:0x1
    v_add_f32_dpp v77, v74, v72 row_ror:8 row_mask:0xf bank_mask:0x8
    s_waitcnt vmcnt(6)
    s_cmp_eq_u32 s65, 2
    s_cbranch_scc1 L_go44
    s_waitcnt vmcnt(4)
    s_cmp_eq_u32 s65, 1
    s_cbranch_scc1 L_go44
    s_waitcnt vmcnt(3)
L_go44:
    buffer_load_dwordx4 v[112:115], v90, s[32:35], s48 offen offset:0 nt
    v_add_f32_dpp v76, v78, v76 row_ror:12 row_mask:0xf bank_mask:0xf
    v_add_f32_dpp v77, v79, v77 row_ror:12 row_mask:0xf bank_mask:0xf
    v_cvt_pk_bf16_f32 v78, v76, v77
    v_lshlrev_b32 v76, 16, v78
    v_and_b32 v77, 0xffff0000, v78
    v_mul_f32 v76, s44, v76
    v_mul_f32 v77, s44, v77
    v_cvt_pk_bf16_f32 v29, v76, v77
    v_lshlrev_b32 v76, 16, v29
    v_and_b32 v77, 0xffff0000, v29
    v_max3_f32 v82, v82, v76, v77
    v_mfma_f32_16x16x32_bf16 v[44:47], v[160:163], v[12:15], 0
    v_mfma_f32_16x16x32_bf16 v[48:51], v[164:167], v[16:19], 0
    v_mfma_f32_16x16x32_bf16 v[52:55], v[168:171], v[20:23], 0
    v_mfma_f32_16x16x32_bf16 v[56:59], v[172:175], v[24:27], 0
    v_mfma_f32_16x16x32_bf16 v[60:63], v[176:179], v[12:15], 0
    v_mfma_f32_16x16x32_bf16 v[64:67], v[180:183], v[16:19], 0
    v_mfma_f32_16x16x32_bf16 v[68:71], v[184:187], v[20:23], 0
    s_waitcnt vmcnt(6)
    s_cmp_eq_u32 s65, 2
    s_cbranch_scc1 L_go45
    s_waitcnt vmcnt(4)
    s_cmp_eq_u32 s65, 1
    s_cbranch_scc1 L_go45
    s_waitcnt vmcnt(3)
L_go45:
    buffer_load_dwordx4 v[116:119], v90, s[32:35], s48 offen offset:1024 nt
    v_mfma_f32_16x16x32_bf16 v[72:75], v[188:191], v[24:27], 0
    v_add_f32_dpp v78, v47, v45 row_ror:8 row_mask:0xf bank_mask:0x2
    v_add_f32_dpp v76, v46, v44 row_ror:8 row_mask:0xf bank_mask:0x1
    v_add_f32_dpp v78, v51, v49 row_ror:8 row_mask:0xf bank_mask:0x4
    v_add_f32_dpp v76, v50, v48 row_ror:8 row_mask:0xf bank_mask:0x2
    v_add_f32_dpp v78, v55, v53 row_ror:8 row_mask:0xf bank_mask:0x8
    v_add_f32_dpp v76, v54, v52 row_ror:8 row_mask:0xf bank_mask:0x4
    v_add_f32_dpp v78, v59, v57 row_ror:8 row_mask:0xf bank_mask:0x1
    v_add_f32_dpp v76, v58, v56 row_ror:8 row_mask:0xf bank_mask:0x8
    v_add_f32_dpp v79, v63, v61 row_ror:8 row_mask:0xf bank_mask:0x2
    v_add_f32_dpp v77, v62, v60 row_ror:8 row_mask:0xf bank_mask:0x1
    v_add_f32_dpp v79, v67, v65 row_ror:8 row_mask:0xf bank_mask:0x4
    v_add_f32_dpp v77, v66, v64 row_ror:8 row_mask:0xf bank_mask:0x2
    v_add_f32_dpp v79, v71, v69 row_ror:8 row_mask:0xf bank_mask:0x8
    v_add_f32_dpp v77, v70, v68 row_ror:8 row_mask:0xf bank_mask:0x4
    v_add_f32_dpp v79, v75, v73 row_ror:8 row_mask:0xf bank_mask:0x1
    v_add_f32_dpp v77, v74, v72 row_ror:8 row_mask:0xf bank_mask:0x8
    s_waitcnt vmcnt(6)
    s_cmp_eq_u32 s65, 2
    s_cbranch_scc1 L_go46
    s_waitcnt vmcnt(4)
    s_cmp_eq_u32 s65, 1
    s_cbranch_scc1 L_go46
    s_waitcnt vmcnt(3)
L_go46:
    buffer_load_dwordx4 v[120:123], v90, s[32:35], s48 offen offset:2048 nt
    v_add_f32_dpp v76, v78, v76 row_ror:12 row_mask:0xf bank_mask:0xf
    v_add_f32_dpp v77, v79, v77 row_ror:12 row_mask:0xf bank_mask:0xf
    v_cvt_pk_bf16_f32 v78, v76, v77
    v_lshlrev_b32 v76, 16, v78
    v_and_b32 v77, 0xffff0000, v78
    v_mul_f32 v76, s44, v76
    v_mul_f32 v77, s44, v77
    v_cvt_pk_bf16_f32 v30, v76, v77
    v_lshlrev_b32 v76, 16, v30
    v_and_b32 v77, 0xffff0000, v30
    v_max3_f32 v82, v82, v76, v77
    v_mfma_f32_16x16x32_bf16 v[44:47], v[192:195], v[12:15], 0
    v_mfma_f32_16x16x32_bf16 v[48:51], v[196:199], v[16:19], 0
    v_mfma_f32_16x16x32_bf16 v[52:55], v[200:203], v[20:23], 0
    v_mfma_f32_16x16x32_bf16 v[56:59], v[204:207], v[24:27], 0
    v_mfma_f32_16x16x32_bf16 v[60:63], v[208:211], v[12:15], 0
    v_mfma_f32_16x16x32_bf16 v[64:67], v[212:215], v[16:19], 0
    v_mfma_f32_16x16x32_bf16 v[68:71], v[216:219], v[20:23], 0
    s_waitcnt vmcnt(6)
    s_cmp_eq_u32 s65, 2
    s_cbranch_scc1 L_go47
    s_waitcnt vmcnt(4)
    s_cmp_eq_u32 s65, 1
    s_cbranch_scc1 L_go47
    s_waitcnt vmcnt(3)
L_go47:
    buffer_load_dwordx4 v[124:127], v90, s[32:35], s48 offen offset:3072 nt
    s_add_u32 s48, s48, 0x20000
    s_bitset0_b32 s48, 21
    s_bitcmp1_b32 s51, 6
    s_cselect_b32 s65, 2, 1
    v_mfma_f32_16x16x32_bf16 v[72:75], v[220:223], v[24:27], 0
    v_add_f32_dpp v78, v47, v45 row_ror:8 row_mask:0xf bank_mask:0x2
    v_add_f32_dpp v76, v46, v44 row_ror:8 row_mask:0xf bank_mask:0x1
    v_add_f32_dpp v78, v51, v49 row_ror:8 row_mask:0xf bank_mask:0x4
    v_add_f32_dpp v76, v50, v48 row_ror:8 row_mask:0xf bank_mask:0x2
    v_add_f32_dpp v78, v55, v53 row_ror:8 row_mask:0xf bank_mask:0x8
    v_add_f32_dpp v76, v54, v52 row_ror:8 row_mask:0xf bank_mask:0x4
    v_add_f32_dpp v78, v59, v57 row_ror:8 row_mask:0xf bank_mask:0x1
    v_add_f32_dpp v76, v58, v56 row_ror:8 row_mask:0xf bank_mask:0x8
    v_add_f32_dpp v79, v63, v61 row_ror:8 row_mask:0xf bank_mask:0x2
    v_add_f32_dpp v77, v62, v60 row_ror:8 row_mask:0xf bank_mask:0x1
    v_add_f32_dpp v79, v67, v65 row_ror:8 row_mask:0xf bank_mask:0x4
    v_add_f32_dpp v77, v66, v64 row_ror:8 row_mask:0xf bank_mask:0x2
    v_add_f32_dpp v79, v71, v69 row_ror:8 row_mask:0xf bank_mask:0x8
    v_add_f32_dpp v77, v70, v68 row_ror:8 row_mask:0xf bank_mask:0x4
    v_add_f32_dpp v79, v75, v73 row_ror:8 row_mask:0xf bank_mask:0x1
    v_add_f32_dpp v77, v74, v72 row_ror:8 row_mask:0xf bank_mask:0x8
    s_waitcnt vmcnt(6)
    s_cmp_eq_u32 s65, 2
    s_cbranch_scc1 L_go48
    s_waitcnt vmcnt(4)
    s_cmp_eq_u32 s65, 1
    s_cbranch_scc1 L_go48
    s_waitcnt vmcnt(3)
L_go48:
    buffer_load_dwordx4 v[128:131], v2, s[32:35], s48 offen offset:0 nt
    v_add_f32_dpp v76, v78, v76 row_ror:12 row_mask:0xf bank_mask:0xf
    v_add_f32_dpp v77, v79, v77 row_ror:12 row_mask:0xf bank_mask:0xf
    v_cvt_pk_bf16_f32 v78, v76, v77
    v_lshlrev_b32 v76, 16, v78
    v_and_b32 v77, 0xffff0000, v78
    v_mul_f32 v76, s44, v76
    v_mul_f32 v77, s44, v77
    v_cvt_pk_bf16_f32 v31, v76, v77
    v_lshlrev_b32 v76, 16, v31
    v_and_b32 v77, 0xffff0000, v31
    v_max3_f32 v82, v82, v76, v77
    v_mfma_f32_16x16x32_bf16 v[44:47], v[224:227], v[12:15], 0
    v_mfma_f32_16x16x32_bf16 v[48:51], v[228:231], v[16:19], 0
    v_mfma_f32_16x16x32_bf16 v[52:55], v[232:235], v[20:23], 0
    v_mfma_f32_16x16x32_bf16 v[56:59], v[236:239], v[24:27], 0
    v_mfma_f32_16x16x32_bf16 v[60:63], v[240:243], v[12:15], 0
    v_mfma_f32_16x16x32_bf16 v[64:67], v[244:247], v[16:19], 0
    v_mfma_f32_16x16x32_bf16 v[68:71], v[248:251], v[20:23], 0
    s_waitcnt vmcnt(6)
    s_cmp_eq_u32 s65, 2
    s_cbranch_scc1 L_go49
    s_waitcnt vmcnt(4)
    s_cmp_eq_u32 s65, 1
    s_cbranch_scc1 L_go49
    s_waitcnt vmcnt(3)
L_go49:
    buffer_load_dwordx4 v[132:135], v2, s[32:35], s48 offen offset:1024 nt
    v_mfma_f32_16x16x32_bf16 v[72:75], v[252:255], v[24:27], 0
    v_add_f32_dpp v78, v47, v45 row_ror:8 row_mask:0xf bank_mask:0x2
    v_add_f32_dpp v76, v46, v44 row_ror:8 row_mask:0xf bank_mask:0x1
    v_add_f32_dpp v78, v51, v49 row_ror:8 row_mask:0xf bank_mask:0x4
    v_add_f32_dpp v76, v50, v48 row_ror:8 row_mask:0xf bank_mask:0x2
    v_add_f32_dpp v78, v55, v53 row_ror:8 row_mask:0xf bank_mask:0x8
    v_add_f32_dpp v76, v54, v52 row_ror:8 row_mask:0xf bank_mask:0x4
    v_add_f32_dpp v78, v59, v57 row_ror:8 row_mask:0xf bank_mask:0x1
    v_add_f32_dpp v76, v58, v56 row_ror:8 row_mask:0xf bank_mask:0x8
    v_add_f32_dpp v79, v63, v61 row_ror:8 row_mask:0xf bank_mask:0x2
    v_add_f32_dpp v77, v62, v60 row_ror:8 row_mask:0xf bank_mask:0x1
    v_add_f32_dpp v79, v67, v65 row_ror:8 row_mask:0xf bank_mask:0x4
    v_add_f32_dpp v77, v66, v64 row_ror:8 row_mask:0xf bank_mask:0x2
    v_add_f32_dpp v79, v71, v69 row_ror:8 row_mask:0xf bank_mask:0x8
    v_add_f32_dpp v77, v70, v68 row_ror:8 row_mask:0xf bank_mask:0x4
    v_add_f32_dpp v79, v75, v73 row_ror:8 row_mask:0xf bank_mask:0x1
    v_add_f32_dpp v77, v74, v72 row_ror:8 row_mask:0xf bank_mask:0x8
    s_waitcnt vmcnt(6)
    s_cmp_eq_u32 s65, 2
    s_cbranch_scc1 L_go50
    s_waitcnt vmcnt(4)
    s_cmp_eq_u32 s65, 1
    s_cbranch_scc1 L_go50
    s_waitcnt vmcnt(3)
L_go50:
    buffer_load_dwordx4 v[136:139], v2, s[32:35], s48 offen offset:2048 nt
    v_add_f32_dpp v76, v78, v76 row_ror:12 row_mask:0xf bank_mask:0xf
    v_add_f32_dpp v77, v79, v77 row_ror:12 row_mask:0xf bank_mask:0xf
    v_cvt_pk_bf16_f32 v78, v76, v77
    v_lshlrev_b32 v76, 16, v78
    v_and_b32 v77, 0xffff0000, v78
    v_mul_f32 v76, s44, v76
    v_mul_f32 v77, s44, v77
    v_cvt_pk_bf16_f32 v32, v76, v77
    v_lshlrev_b32 v76, 16, v32
    v_and_b32 v77, 0xffff0000, v32
    v_max3_f32 v82, v82, v76, v77
    v_mfma_f32_16x16x32_bf16 v[44:47], v[96:99], v[12:15], 0
    v_mfma_f32_16x16x32_bf16 v[48:51], v[100:103], v[16:19], 0
    v_mfma_f32_16x16x32_bf16 v[52:55], v[104:107], v[20:23], 0
    v_mfma_f32_16x16x32_bf16 v[56:59], v[108:111], v[24:27], 0
    s_waitcnt vmcnt(6)
    s_cmp_eq_u32 s65, 2
    s_cbranch_scc1 L_go51
    s_waitcnt vmcnt(4)
    s_cmp_eq_u32 s65, 1
    s_cbranch_scc1 L_go51
    s_waitcnt vmcnt(3)
L_go51:
    buffer_load_dwordx4 v[140:143], v2, s[32:35], s48 offen offset:3072 nt
    v_mfma_f32_16x16x32_bf16 v[60:63], v[112:115], v[12:15], 0
    s_waitcnt vmcnt(6)
    s_cmp_eq_u32 s65, 2
    s_cbranch_scc1 L_go52
    s_waitcnt vmcnt(4)
    s_cmp_eq_u32 s65, 1
    s_cbranch_scc1 L_go52
    s_waitcnt vmcnt(3)
L_go52:
    buffer_load_dwordx4 v[144:147], v90, s[32:35], s48 offen offset:0 nt
    v_mfma_f32_16x16x32_bf16 v[64:67], v[116:119], v[16:19], 0
    s_waitcnt vmcnt(6)
    s_cmp_eq_u32 s65, 2
    s_cbranch_scc1 L_go53
    s_waitcnt vmcnt(4)
    s_cmp_eq_u32 s65, 1
    s_cbranch_scc1 L_go53
    s_waitcnt vmcnt(3)
L_go53:
    buffer_load_dwordx4 v[148:151], v90, s[32:35], s48 offen offset:1024 nt
    v_mfma_f32_16x16x32_bf16 v[68:71], v[120:123], v[20:23], 0
    s_waitcnt vmcnt(6)
    s_cmp_eq_u32 s65, 2
    s_cbranch_scc1 L_go54
    s_waitcnt vmcnt(4)
    s_cmp_eq_u32 s65, 1
    s_cbranch_scc1 L_go54
    s_waitcnt vmcnt(3)
L_go54:
    buffer_load_dwordx4 v[152:155], v90, s[32:35], s48 offen offset:2048 nt
    v_mfma_f32_16x16x32_bf16 v[72:75], v[124:127], v[24:27], 0
    v_add_f32_dpp v78, v47, v45 row_ror:8 row_mask:0xf bank_mask:0x2
    v_add_f32_dpp v76, v46, v44 row_ror:8 row_mask:0xf bank_mask:0x1
    v_add_f32_dpp v78, v51, v49 row_ror:8 row_mask:0xf bank_mask:0x4
    v_add_f32_dpp v76, v50, v48 row_ror:8 row_mask:0xf bank_mask:0x2
    v_add_f32_dpp v78, v55, v53 row_ror:8 row_mask:0xf bank_mask:0x8
    v_add_f32_dpp v76, v54, v52 row_ror:8 row_mask:0xf bank_mask:0x4
    v_add_f32_dpp v78, v59, v57 row_ror:8 row_mask:0xf bank_mask:0x1
    v_add_f32_dpp v76, v58, v56 row_ror:8 row_mask:0xf bank_mask:0x8
    v_add_f32_dpp v79, v63, v61 row_ror:8 row_mask:0xf bank_mask:0x2
    v_add_f32_dpp v77, v62, v60 row_ror:8 row_mask:0xf bank_mask:0x1
    v_add_f32_dpp v79, v67, v65 row_ror:8 row_mask:0xf bank_mask:0x4
    v_add_f32_dpp v77, v66, v64 row_ror:8 row_mask:0xf bank_mask:0x2
    v_add_f32_dpp v79, v71, v69 row_ror:8 row_mask:0xf bank_mask:0x8
    v_add_f32_dpp v77, v70, v68 row_ror:8 row_mask:0xf bank_mask:0x4
    v_add_f32_dpp v79, v75, v73 row_ror:8 row_mask:0xf bank_mask:0x1
    v_add_f32_dpp v77, v74, v72 row_ror:8 row_mask:0xf bank_mask:0x8
    s_waitcnt vmcnt(6)
    s_cmp_eq_u32 s65, 2
    s_cbranch_scc1 L_go55
    s_waitcnt vmcnt(4)
    s_cmp_eq_u32 s65, 1
    s_cbranch_scc1 L_go55
    s_waitcnt vmcnt(3)
L_go55:
    buffer_load_dwordx4 v[156:159], v90, s[32:35], s48 offen offset:3072 nt
    s_add_u32 s48, s48, 0x20000
    s_bitset0_b32 s48, 21
    s_bitcmp1_b32 s51, 7
    s_cselect_b32 s65, 2, 1
    v_add_f32_dpp v76, v78, v76 row_ror:12 row_mask:0xf bank_mask:0xf
    v_add_f32_dpp v77, v79, v77 row_ror:12 row_mask:0xf bank_mask:0xf
    v_cvt_pk_bf16_f32 v78, v76, v77
    v_lshlrev_b32 v76, 16, v78
    v_and_b32 v77, 0xffff0000, v78
    v_mul_f32 v76, s44, v76
    v_mul_f32 v77, s44, v77
    v_cvt_pk_bf16_f32 v33, v76, v77
    v_lshlrev_b32 v76, 16, v33
    v_and_b32 v77, 0xffff0000, v33
    v_max3_f32 v82, v82, v76, v77
    v_mfma_f32_16x16x32_bf16 v[44:47], v[128:131], v[12:15], 0
    s_waitcnt vmcnt(6)
    s_cmp_eq_u32 s65, 2
    s_cbranch_scc1 L_go56
    s_waitcnt vmcnt(4)
    s_cmp_eq_u32 s65, 1
    s_cbranch_scc1 L_go56
    s_waitcnt vmcnt(3)
L_go56:
    buffer_load_dwordx4 v[160:163], v2, s[32:35], s48 offen offset:0 nt
    v_mfma_f32_16x16x32_bf16 v[48:51], v[132:135], v[16:19], 0
    s_waitcnt vmcnt(6)
    s_cmp_eq_u32 s65, 2
    s_cbranch_scc1 L_go57
    s_waitcnt vmcnt(4)
    s_cmp_eq_u32 s65, 1
    s_cbranch_scc1 L_go57
    s_waitcnt vmcnt(3)
L_go57:
    buffer_load_dwordx4 v[164:167], v2, s[32:35], s48 offen offset:1024 nt
    v_mfma_f32_16x16x32_bf16 v[52:55], v[136:139], v[20:23], 0
    s_waitcnt vmcnt(6)
    s_cmp_eq_u32 s65, 2
    s_cbranch_scc1 L_go58
    s_waitcnt vmcnt(4)
    s_cmp_eq_u32 s65, 1
    s_cbranch_scc1 L_go58
    s_waitcnt vmcnt(3)
L_go58:
    buffer_load_dwordx4 v[168:171], v2, s[32:35], s48 offen offset:2048 nt
    v_mfma_f32_16x16x32_bf16 v[56:59], v[140:143], v[24:27], 0
    s_waitcnt vmcnt(6)
    s_cmp_eq_u32 s65, 2
    s_cbranch_scc1 L_go59
    s_waitcnt vmcnt(4)
    s_cmp_eq_u32 s65, 1
    s_cbranch_scc1 L_go59
    s_waitcnt vmcnt(3)
L_go59:
    buffer_load_dwordx4 v[172:175], v2, s[32:35], s48 offen offset:3072 nt
    v_mfma_f32_16x16x32_bf16 v[60:63], v[144:147], v[12:15], 0
    s_waitcnt vmcnt(6)
    s_cmp_eq_u32 s65, 2
    s_cbranch_scc1 L_go60
    s_waitcnt vmcnt(4)
    s_cmp_eq_u32 s65, 1
    s_cbranch_scc1 L_go60
    s_waitcnt vmcnt(3)
L_go60:
    buffer_load_dwordx4 v[176:179], v90, s[32:35], s48 offen offset:0 nt
    v_mfma_f32_16x16x32_bf16 v[64:67], v[148:151], v[16:19], 0
    s_waitcnt vmcnt(6)
    s_cmp_eq_u32 s65, 2
    s_cbranch_scc1 L_go61
    s_waitcnt vmcnt(4)
    s_cmp_eq_u32 s65, 1
    s_cbranch_scc1 L_go61
    s_waitcnt vmcnt(3)
L_go61:
    buffer_load_dwordx4 v[180:183], v90, s[32:35], s48 offen offset:1024 nt
    v_mfma_f32_16x16x32_bf16 v[68:71], v[152:155], v[20:23], 0
    s_waitcnt vmcnt(6)
    s_cmp_eq_u32 s65, 2
    s_cbranch_scc1 L_go62
    s_waitcnt vmcnt(4)
    s_cmp_eq_u32 s65, 1
    s_cbranch_scc1 L_go62
    s_waitcnt vmcnt(3)
L_go62:
    buffer_load_dwordx4 v[184:187], v90, s[32:35], s48 offen offset:2048 nt
    v_mfma_f32_16x16x32_bf16 v[72:75], v[156:159], v[24:27], 0
    v_add_f32_dpp v78, v47, v45 row_ror:8 row_mask:0xf bank_mask:0x2
    v_add_f32_dpp v76, v46, v44 row_ror:8 row_mask:0xf bank_mask:0x1
    v_add_f32_dpp v78, v51, v49 row_ror:8 row_mask:0xf bank_mask:0x4
    v_add_f32_dpp v76, v50, v48 row_ror:8 row_mask:0xf bank_mask:0x2
    v_add_f32_dpp v78, v55, v53 row_ror:8 row_mask:0xf bank_mask:0x8
    v_add_f32_dpp v76, v54, v52 row_ror:8 row_mask:0xf bank_mask:0x4
    v_add_f32_dpp v78, v59, v57 row_ror:8 row_mask:0xf bank_mask:0x1
    v_add_f32_dpp v76, v58, v56 row_ror:8 row_mask:0xf bank_mask:0x8
    v_add_f32_dpp v79, v63, v61 row_ror:8 row_mask:0xf bank_mask:0x2
    v_add_f32_dpp v77, v62, v60 row_ror:8 row_mask:0xf bank_mask:0x1
    v_add_f32_dpp v79, v67, v65 row_ror:8 row_mask:0xf bank_mask:0x4
    v_add_f32_dpp v77, v66, v64 row_ror:8 row_mask:0xf bank_mask:0x2
    v_add_f32_dpp v79, v71, v69 row_ror:8 row_mask:0xf bank_mask:0x8
    v_add_f32_dpp v77, v70, v68 row_ror:8 row_mask:0xf bank_mask:0x4
    v_add_f32_dpp v79, v75, v73 row_ror:8 row_mask:0xf bank_mask:0x1
    v_add_f32_dpp v77, v74, v72 row_ror:8 row_mask:0xf bank_mask:0x8
    s_waitcnt vmcnt(6)
    s_cmp_eq_u32 s65, 2
    s_cbranch_scc1 L_go63
    s_waitcnt vmcnt(4)
    s_cmp_eq_u32 s65, 1
    s_cbranch_scc1 L_go63
    s_waitcnt vmcnt(3)
L_go63:
    buffer_load_dwordx4 v[188:191], v90, s[32:35], s48 offen offset:3072 nt
    s_add_u32 s48, s48, 0x20000
    s_bitset0_b32 s48, 21
    s_bitcmp1_b32 s51, 8
    s_cselect_b32 s65, 2, 1
    v_add_f32_dpp v76, v78, v76 row_ror:12 row_mask:0xf bank_mask:0xf
    v_add_f32_dpp v77, v79, v77 row_ror:12 row_mask:0xf bank_mask:0xf
    v_cvt_pk_bf16_f32 v78, v76, v77
    v_lshlrev_b32 v76, 16, v78
    v_and_b32 v77, 0xffff0000, v78
    v_mul_f32 v76, s44, v76
    v_mul_f32 v77, s44, v77
    v_cvt_pk_bf16_f32 v34, v76, v77
    v_lshlrev_b32 v76, 16, v34
    v_and_b32 v77, 0xffff0000, v34
    v_max3_f32 v82, v82, v76, v77
    v_mfma_f32_16x16x32_bf16 v[44:47], v[160:163], v[12:15], 0
    s_waitcnt vmcnt(6)
    s_cmp_eq_u32 s65, 2
    s_cbranch_scc1 L_go64
    s_waitcnt vmcnt(4)
    s_cmp_eq_u32 s65, 1
    s_cbranch_scc1 L_go64
    s_waitcnt vmcnt(3)
L_go64:
    buffer_load_dwordx4 v[192:195], v2, s[32:35], s48 offen offset:0 nt
    v_mfma_f32_16x16x32_bf16 v[48:51], v[164:167], v[16:19], 0
    s_waitcnt vmcnt(6)
    s_cmp_eq_u32 s65, 2
    s_cbranch_scc1 L_go65
    s_waitcnt vmcnt(4)
    s_cmp_eq_u32 s65, 1
    s_cbranch_scc1 L_go65
    s_waitcnt vmcnt(3)
L_go65:
    buffer_load_dwordx4 v[196:199], v2, s[32:35], s48 offen offset:1024 nt
    v_mfma_f32_16x16x32_bf16 v[52:55], v[168:171], v[20:23], 0
    s_waitcnt vmcnt(6)
    s_cmp_eq_u32 s65, 2
    s_cbranch_scc1 L_go66
    s_waitcnt vmcnt(4)
    s_cmp_eq_u32 s65, 1
    s_cbranch_scc1 L_go66
    s_waitcnt vmcnt(3)
L_go66:
    buffer_load_dwordx4 v[200:203], v2, s[32:35], s48 offen offset:2048 nt
    v_mfma_f32_16x16x32_bf16 v[56:59], v[172:175], v[24:27], 0
    s_waitcnt vmcnt(6)
    s_cmp_eq_u32 s65, 2
    s_cbranch_scc1 L_go67
    s_waitcnt vmcnt(4)
    s_cmp_eq_u32 s65, 1
    s_cbranch_scc1 L_go67
    s_waitcnt vmcnt(3)
L_go67:
    buffer_load_dwordx4 v[204:207], v2, s[32:35], s48 offen offset:3072 nt
    v_mfma_f32_16x16x32_bf16 v[60:63], v[176:179], v[12:15], 0
    s_waitcnt vmcnt(6)
    s_cmp_eq_u32 s65, 2
    s_cbranch_scc1 L_go68
    s_waitcnt vmcnt(4)
    s_cmp_eq_u32 s65, 1
    s_cbranch_scc1 L_go68
    s_waitcnt vmcnt(3)
L_go68:
    buffer_load_dwordx4 v[208:211], v90, s[32:35], s48 offen offset:0 nt
    v_mfma_f32_16x16x32_bf16 v[64:67], v[180:183], v[16:19], 0
    s_waitcnt vmcnt(6)
    s_cmp_eq_u32 s65, 2
    s_cbranch_scc1 L_go69
    s_waitcnt vmcnt(4)
    s_cmp_eq_u32 s65, 1
    s_cbranch_scc1 L_go69
    s_waitcnt vmcnt(3)
L_go69:
    buffer_load_dwordx4 v[212:215], v90, s[32:35], s48 offen offset:1024 nt
    v_mfma_f32_16x16x32_bf16 v[68:71], v[184:187], v[20:23], 0
    s_waitcnt vmcnt(6)
    s_cmp_eq_u32 s65, 2
    s_cbranch_scc1 L_go70
    s_waitcnt vmcnt(4)
    s_cmp_eq_u32 s65, 1
    s_cbranch_scc1 L_go70
    s_waitcnt vmcnt(3)
L_go70:
    buffer_load_dwordx4 v[216:219], v90, s[32:35], s48 offen offset:2048 nt
    v_mfma_f32_16x16x32_bf16 v[72:75], v[188:191], v[24:27], 0
    v_add_f32_dpp v78, v47, v45 row_ror:8 row_mask:0xf bank_mask:0x2
    v_add_f32_dpp v76, v46, v44 row_ror:8 row_mask:0xf bank_mask:0x1
    v_add_f32_dpp v78, v51, v49 row_ror:8 row_mask:0xf bank_mask:0x4
    v_add_f32_dpp v76, v50, v48 row_ror:8 row_mask:0xf bank_mask:0x2
    v_add_f32_dpp v78, v55, v53 row_ror:8 row_mask:0xf bank_mask:0x8
    v_add_f32_dpp v76, v54, v52 row_ror:8 row_mask:0xf bank_mask:0x4
    v_add_f32_dpp v78, v59, v57 row_ror:8 row_mask:0xf bank_mask:0x1
    v_add_f32_dpp v76, v58, v56 row_ror:8 row_mask:0xf bank_mask:0x8
    v_add_f32_dpp v79, v63, v61 row_ror:8 row_mask:0xf bank_mask:0x2
    v_add_f32_dpp v77, v62, v60 row_ror:8 row_mask:0xf bank_mask:0x1
    v_add_f32_dpp v79, v67, v65 row_ror:8 row_mask:0xf bank_mask:0x4
    v_add_f32_dpp v77, v66, v64 row_ror:8 row_mask:0xf bank_mask:0x2
    v_add_f32_dpp v79, v71, v69 row_ror:8 row_mask:0xf bank_mask:0x8
    v_add_f32_dpp v77, v70, v68 row_ror:8 row_mask:0xf bank_mask:0x4
    v_add_f32_dpp v79, v75, v73 row_ror:8 row_mask:0xf bank_mask:0x1
    v_add_f32_dpp v77, v74, v72 row_ror:8 row_mask:0xf bank_mask:0x8
    s_waitcnt vmcnt(6)
    s_cmp_eq_u32 s65, 2
    s_cbranch_scc1 L_go71
    s_waitcnt vmcnt(4)
    s_cmp_eq_u32 s65, 1
    s_cbranch_scc1 L_go71
    s_waitcnt vmcnt(3)
L_go71:
    buffer_load_dwordx4 v[220:223], v90, s[32:35], s48 offen offset:3072 nt
    s_add_u32 s48, s48, 0x20000
    s_bitset0_b32 s48, 21
    s_bitcmp1_b32 s51, 9
    s_cselect_b32 s65, 2, 1
    v_add_f32_dpp v76, v78, v76 row_ror:12 row_mask:0xf bank_mask:0xf
    v_add_f32_dpp v77, v79, v77 row_ror:12 row_mask:0xf bank_mask:0xf
    v_cvt_pk_bf16_f32 v78, v76, v77
    v_lshlrev_b32 v76, 16, v78
    v_and_b32 v77, 0xffff0000, v78
    v_mul_f32 v76, s44, v76
    v_mul_f32 v77, s44, v77
    v_cvt_pk_bf16_f32 v35, v76, v77
    v_lshlrev_b32 v76, 16, v35
    v_and_b32 v77, 0xffff0000, v35
    v_max3_f32 v82, v82, v76, v77
    v_mfma_f32_16x16x32_bf16 v[44:47], v[192:195], v[12:15], 0
    s_waitcnt vmcnt(6)
    s_cmp_eq_u32 s65, 2
    s_cbranch_scc1 L_go72
    s_waitcnt vmcnt(4)
    s_cmp_eq_u32 s65, 1
    s_cbranch_scc1 L_go72
    s_waitcnt vmcnt(3)
L_go72:
    buffer_load_dwordx4 v[224:227], v2, s[32:35], s48 offen offset:0 nt
    v_mfma_f32_16x16x32_bf16 v[48:51], v[196:199], v[16:19], 0
    s_waitcnt vmcnt(6)
    s_cmp_eq_u32 s65, 2
    s_cbranch_scc1 L_go73
    s_waitcnt vmcnt(4)
    s_cmp_eq_u32 s65, 1
    s_cbranch_scc1 L_go73
    s_waitcnt vmcnt(3)
L_go73:
    buffer_load_dwordx4 v[228:231], v2, s[32:35], s48 offen offset:1024 nt
    v_mfma_f32_16x16x32_bf16 v[52:55], v[200:203], v[20:23], 0
    s_waitcnt vmcnt(6)
    s_cmp_eq_u32 s65, 2
    s_cbranch_scc1 L_go74
    s_waitcnt vmcnt(4)
    s_cmp_eq_u32 s65, 1
    s_cbranch_scc1 L_go74
    s_waitcnt vmcnt(3)
L_go74:
    buffer_load_dwordx4 v[232:235], v2, s[32:35], s48 offen offset:2048 nt
    v_mfma_f32_16x16x32_bf16 v[56:59], v[204:207], v[24:27], 0
    s_waitcnt vmcnt(6)
    s_cmp_eq_u32 s65, 2
    s_cbranch_scc1 L_go75
    s_waitcnt vmcnt(4)
    s_cmp_eq_u32 s65, 1
    s_cbranch_scc1 L_go75
    s_waitcnt vmcnt(3)
L_go75:
    buffer_load_dwordx4 v[236:239], v2, s[32:35], s48 offen offset:3072 nt
    v_mfma_f32_16x16x32_bf16 v[60:63], v[208:211], v[12:15], 0
    s_waitcnt vmcnt(6)
    s_cmp_eq_u32 s65, 2
    s_cbranch_scc1 L_go76
    s_waitcnt vmcnt(4)
    s_cmp_eq_u32 s65, 1
    s_cbranch_scc1 L_go76
    s_waitcnt vmcnt(3)
L_go76:
    buffer_load_dwordx4 v[240:243], v90, s[32:35], s48 offen offset:0 nt
    v_mfma_f32_16x16x32_bf16 v[64:67], v[212:215], v[16:19], 0
    s_waitcnt vmcnt(6)
    s_cmp_eq_u32 s65, 2
    s_cbranch_scc1 L_go77
    s_waitcnt vmcnt(4)
    s_cmp_eq_u32 s65, 1
    s_cbranch_scc1 L_go77
    s_waitcnt vmcnt(3)
L_go77:
    buffer_load_dwordx4 v[244:247], v90, s[32:35], s48 offen offset:1024 nt
    v_mfma_f32_16x16x32_bf16 v[68:71], v[216:219], v[20:23], 0
    s_waitcnt vmcnt(6)
    s_cmp_eq_u32 s65, 2
    s_cbranch_scc1 L_go78
    s_waitcnt vmcnt(4)
    s_cmp_eq_u32 s65, 1
    s_cbranch_scc1 L_go78
    s_waitcnt vmcnt(3)
L_go78:
    buffer_load_dwordx4 v[248:251], v90, s[32:35], s48 offen offset:2048 nt
    v_mfma_f32_16x16x32_bf16 v[72:75], v[220:223], v[24:27], 0
    v_add_f32_dpp v78, v47, v45 row_ror:8 row_mask:0xf bank_mask:0x2
    v_add_f32_dpp v76, v46, v44 row_ror:8 row_mask:0xf bank_mask:0x1
    v_add_f32_dpp v78, v51, v49 row_ror:8 row_mask:0xf bank_mask:0x4
    v_add_f32_dpp v76, v50, v48 row_ror:8 row_mask:0xf bank_mask:0x2
    v_add_f32_dpp v78, v55, v53 row_ror:8 row_mask:0xf bank_mask:0x8
    v_add_f32_dpp v76, v54, v52 row_ror:8 row_mask:0xf bank_mask:0x4
    v_add_f32_dpp v78, v59, v57 row_ror:8 row_mask:0xf bank_mask:0x1
    v_add_f32_dpp v76, v58, v56 row_ror:8 row_mask:0xf bank_mask:0x8
    v_add_f32_dpp v79, v63, v61 row_ror:8 row_mask:0xf bank_mask:0x2
    v_add_f32_dpp v77, v62, v60 row_ror:8 row_mask:0xf bank_mask:0x1
    v_add_f32_dpp v79, v67, v65 row_ror:8 row_mask:0xf bank_mask:0x4
    v_add_f32_dpp v77, v66, v64 row_ror:8 row_mask:0xf bank_mask:0x2
    v_add_f32_dpp v79, v71, v69 row_ror:8 row_mask:0xf bank_mask:0x8
    v_add_f32_dpp v77, v70, v68 row_ror:8 row_mask:0xf bank_mask:0x4
    v_add_f32_dpp v79, v75, v73 row_ror:8 row_mask:0xf bank_mask:0x1
    v_add_f32_dpp v77, v74, v72 row_ror:8 row_mask:0xf bank_mask:0x8
    s_waitcnt vmcnt(6)
    s_cmp_eq_u32 s65, 2
    s_cbranch_scc1 L_go79
    s_waitcnt vmcnt(4)
    s_cmp_eq_u32 s65, 1
    s_cbranch_scc1 L_go79
    s_waitcnt vmcnt(3)
L_go79:
    buffer_load_dwordx4 v[252:255], v90, s[32:35], s48 offen offset:3072 nt
    s_add_u32 s48, s48, 0x20000
    s_bitset0_b32 s48, 21
    s_bitcmp1_b32 s51, 10
    s_cselect_b32 s65, 2, 1
    v_add_f32_dpp v76, v78, v76 row_ror:12 row_mask:0xf bank_mask:0xf
    v_add_f32_dpp v77, v79, v77 row_ror:12 row_mask:0xf bank_mask:0xf
    v_cvt_pk_bf16_f32 v78, v76, v77
    v_lshlrev_b32 v76, 16, v78
    v_and_b32 v77, 0xffff0000, v78
    v_mul_f32 v76, s44, v76
    v_mul_f32 v77, s44, v77
    v_cvt_pk_bf16_f32 v36, v76, v77
    v_lshlrev_b32 v76, 16, v36
    v_and_b32 v77, 0xffff0000, v36
    v_max3_f32 v82, v82, v76, v77
    v_mfma_f32_16x16x32_bf16 v[44:47], v[224:227], v[12:15], 0
    s_waitcnt vmcnt(6)
    s_cmp_eq_u32 s65, 2
    s_cbranch_scc1 L_go80
    s_waitcnt vmcnt(4)
    s_cmp_eq_u32 s65, 1
    s_cbranch_scc1 L_go80
    s_waitcnt vmcnt(3)
L_go80:
    buffer_load_dwordx4 v[96:99], v2, s[32:35], s48 offen offset:0 nt
    v_mfma_f32_16x16x32_bf16 v[48:51], v[228:231], v[16:19], 0
    s_waitcnt vmcnt(6)
    s_cmp_eq_u32 s65, 2
    s_cbranch_scc1 L_go81
    s_waitcnt vmcnt(4)
    s_cmp_eq_u32 s65, 1
    s_cbranch_scc1 L_go81
    s_waitcnt vmcnt(3)
L_go81:
    buffer_load_dwordx4 v[100:103], v2, s[32:35], s48 offen offset:1024 nt
    v_mfma_f32_16x16x32_bf16 v[52:55], v[232:235], v[20:23], 0
    s_waitcnt vmcnt(6)
    s_cmp_eq_u32 s65, 2
    s_cbranch_scc1 L_go82
    s_waitcnt vmcnt(4)
    s_cmp_eq_u32 s65, 1
    s_cbranch_scc1 L_go82
    s_waitcnt vmcnt(3)
L_go82:
    buffer_load_dwordx4 v[104:107], v2, s[32:35], s48 offen offset:2048 nt
    v_mfma_f32_16x16x32_bf16 v[56:59], v[236:239], v[24:27], 0
    s_waitcnt vmcnt(6)
    s_cmp_eq_u32 s65, 2
    s_cbranch_scc1 L_go83
    s_waitcnt vmcnt(4)
    s_cmp_eq_u32 s65, 1
    s_cbranch_scc1 L_go83
    s_waitcnt vmcnt(3)
L_go83:
    buffer_load_dwordx4 v[108:111], v2, s[32:35], s48 offen offset:3072 nt
    v_mfma_f32_16x16x32_bf16 v[60:63], v[240:243], v[12:15], 0
    s_waitcnt vmcnt(6)
    s_cmp_eq_u32 s65, 2
    s_cbranch_scc1 L_go84
    s_waitcnt vmcnt(4)
    s_cmp_eq_u32 s65, 1
    s_cbranch_scc1 L_go84
    s_waitcnt vmcnt(3)
L_go84:
    buffer_load_dwordx4 v[112:115], v90, s[32:35], s48 offen offset:0 nt
    v_mfma_f32_16x16x32_bf16 v[64:67], v[244:247], v[16:19], 0
    s_waitcnt vmcnt(6)
    s_cmp_eq_u32 s65, 2
    s_cbranch_scc1 L_go85
    s_waitcnt vmcnt(4)
    s_cmp_eq_u32 s65, 1
    s_cbranch_scc1 L_go85
    s_waitcnt vmcnt(3)
L_go85:
    buffer_load_dwordx4 v[116:119], v90, s[32:35], s48 offen offset:1024 nt
    v_mfma_f32_16x16x32_bf16 v[68:71], v[248:251], v[20:23], 0
    s_waitcnt vmcnt(6)
    s_cmp_eq_u32 s65, 2
    s_cbranch_scc1 L_go86
    s_waitcnt vmcnt(4)
    s_cmp_eq_u32 s65, 1
    s_cbranch_scc1 L_go86
    s_waitcnt vmcnt(3)
L_go86:
    buffer_load_dwordx4 v[120:123], v90, s[32:35], s48 offen offset:2048 nt
    v_mfma_f32_16x16x32_bf16 v[72:75], v[252:255], v[24:27], 0
    v_add_f32_dpp v78, v47, v45 row_ror:8 row_mask:0xf bank_mask:0x2
    v_add_f32_dpp v76, v46, v44 row_ror:8 row_mask:0xf bank_mask:0x1
    v_add_f32_dpp v78, v51, v49 row_ror:8 row_mask:0xf bank_mask:0x4
    v_add_f32_dpp v76, v50, v48 row_ror:8 row_mask:0xf bank_mask:0x2
    v_add_f32_dpp v78, v55, v53 row_ror:8 row_mask:0xf bank_mask:0x8
    v_add_f32_dpp v76, v54, v52 row_ror:8 row_mask:0xf bank_mask:0x4
    v_add_f32_dpp v78, v59, v57 row_ror:8 row_mask:0xf bank_mask:0x1
    v_add_f32_dpp v76, v58, v56 row_ror:8 row_mask:0xf bank_mask:0x8
    v_add_f32_dpp v79, v63, v61 row_ror:8 row_mask:0xf bank_mask:0x2
    v_add_f32_dpp v77, v62, v60 row_ror:8 row_mask:0xf bank_mask:0x1
    v_add_f32_dpp v79, v67, v65 row_ror:8 row_mask:0xf bank_mask:0x4
    v_add_f32_dpp v77, v66, v64 row_ror:8 row_mask:0xf bank_mask:0x2
    v_add_f32_dpp v79, v71, v69 row_ror:8 row_mask:0xf bank_mask:0x8
    v_add_f32_dpp v77, v70, v68 row_ror:8 row_mask:0xf bank_mask:0x4
    v_add_f32_dpp v79, v75, v73 row_ror:8 row_mask:0xf bank_mask:0x1
    v_add_f32_dpp v77, v74, v72 row_ror:8 row_mask:0xf bank_mask:0x8
    s_waitcnt vmcnt(6)
    s_cmp_eq_u32 s65, 2
    s_cbranch_scc1 L_go87
    s_waitcnt vmcnt(4)
    s_cmp_eq_u32 s65, 1
    s_cbranch_scc1 L_go87
    s_waitcnt vmcnt(3)
L_go87:
    buffer_load_dwordx4 v[124:127], v90, s[32:35], s48 offen offset:3072 nt
    s_add_u32 s48, s48, 0x20000
    s_bitset0_b32 s48, 21
    s_bitcmp1_b32 s51, 11
    s_cselect_b32 s65, 2, 1
    v_add_f32_dpp v76, v78, v76 row_ror:12 row_mask:0xf bank_mask:0xf
    v_add_f32_dpp v77, v79, v77 row_ror:12 row_mask:0xf bank_mask:0xf
    v_cvt_pk_bf16_f32 v78, v76, v77
    v_lshlrev_b32 v76, 16, v78
    v_and_b32 v77, 0xffff0000, v78
    v_mul_f32 v76, s44, v76
    v_mul_f32 v77, s44, v77
    v_cvt_pk_bf16_f32 v37, v76, v77
    v_lshlrev_b32 v76, 16, v37
    v_and_b32 v77, 0xffff0000, v37
    v_max3_f32 v82, v82, v76, v77
    v_mfma_f32_16x16x32_bf16 v[44:47], v[96:99], v[12:15], 0
    s_waitcnt vmcnt(6)
    s_cmp_eq_u32 s65, 2
    s_cbranch_scc1 L_go88
    s_waitcnt vmcnt(4)
    s_cmp_eq_u32 s65, 1
    s_cbranch_scc1 L_go88
    s_waitcnt vmcnt(3)
L_go88:
    buffer_load_dwordx4 v[128:131], v2, s[32:35], s48 offen offset:0 nt
    ds_add_u32 v94, v95 offset:20
    v_mfma_f32_16x16x32_bf16 v[48:51], v[100:103], v[16:19], 0
    s_waitcnt vmcnt(6)
    s_cmp_eq_u32 s65, 2
    s_cbranch_scc1 L_go89
    s_waitcnt vmcnt(4)
    s_cmp_eq_u32 s65, 1
    s_cbranch_scc1 L_go89
    s_waitcnt vmcnt(3)
L_go89:
    buffer_load_dwordx4 v[132:135], v2, s[32:35], s48 offen offset:1024 nt
    v_mfma_f32_16x16x32_bf16 v[52:55], v[104:107], v[20:23], 0
    s_waitcnt vmcnt(6)
    s_cmp_eq_u32 s65, 2
    s_cbranch_scc1 L_go90
    s_waitcnt vmcnt(4)
    s_cmp_eq_u32 s65, 1
    s_cbranch_scc1 L_go90
    s_waitcnt vmcnt(3)
L_go90:
    buffer_load_dwordx4 v[136:139], v2, s[32:35], s48 offen offset:2048 nt
    v_mfma_f32_16x16x32_bf16 v[56:59], v[108:111], v[24:27], 0
    s_waitcnt vmcnt(6)
    s_cmp_eq_u32 s65, 2
    s_cbranch_scc1 L_go91
    s_waitcnt vmcnt(4)
    s_cmp_eq_u32 s65, 1
    s_cbranch_scc1 L_go91
    s_waitcnt vmcnt(3)
L_go91:
    buffer_load_dwordx4 v[140:143], v2, s[32:35], s48 offen offset:3072 nt
    v_mfma_f32_16x16x32_bf16 v[60:63], v[112:115], v[12:15], 0
    s_waitcnt vmcnt(6)
    s_cmp_eq_u32 s65, 2
    s_cbranch_scc1 L_go92
    s_waitcnt vmcnt(4)
    s_cmp_eq_u32 s65, 1
    s_cbranch_scc1 L_go92
    s_waitcnt vmcnt(3)
L_go92:
    buffer_load_dwordx4 v[144:147], v90, s[32:35], s48 offen offset:0 nt
    v_mfma_f32_16x16x32_bf16 v[64:67], v[116:119], v[16:19], 0
    s_waitcnt vmcnt(6)
    s_cmp_eq_u32 s65, 2
    s_cbranch_scc1 L_go93
    s_waitcnt vmcnt(4)
    s_cmp_eq_u32 s65, 1
    s_cbranch_scc1 L_go93
    s_waitcnt vmcnt(3)
L_go93:
    buffer_load_dwordx4 v[148:151], v90, s[32:35], s48 offen offset:1024 nt
    v_mfma_f32_16x16x32_bf16 v[68:71], v[120:123], v[20:23], 0
    s_waitcnt vmcnt(6)
    s_cmp_eq_u32 s65, 2
    s_cbranch_scc1 L_go94
    s_waitcnt vmcnt(4)
    s_cmp_eq_u32 s65, 1
    s_cbranch_scc1 L_go94
    s_waitcnt vmcnt(3)
L_go94:
    buffer_load_dwordx4 v[152:155], v90, s[32:35], s48 offen offset:2048 nt
    v_mfma_f32_16x16x32_bf16 v[72:75], v[124:127], v[24:27], 0
    v_add_f32_dpp v78, v47, v45 row_ror:8 row_mask:0xf bank_mask:0x2
    v_add_f32_dpp v76, v46, v44 row_ror:8 row_mask:0xf bank_mask:0x1
    v_add_f32_dpp v78, v51, v49 row_ror:8 row_mask:0xf bank_mask:0x4
    v_add_f32_dpp v76, v50, v48 row_ror:8 row_mask:0xf bank_mask:0x2
    v_add_f32_dpp v78, v55, v53 row_ror:8 row_mask:0xf bank_mask:0x8
    v_add_f32_dpp v76, v54, v52 row_ror:8 row_mask:0xf bank_mask:0x4
    v_add_f32_dpp v78, v59, v57 row_ror:8 row_mask:0xf bank_mask:0x1
    v_add_f32_dpp v76, v58, v56 row_ror:8 row_mask:0xf bank_mask:0x8
    v_add_f32_dpp v79, v63, v61 row_ror:8 row_mask:0xf bank_mask:0x2
    v_add_f32_dpp v77, v62, v60 row_ror:8 row_mask:0xf bank_mask:0x1
    v_add_f32_dpp v79, v67, v65 row_ror:8 row_mask:0xf bank_mask:0x4
    v_add_f32_dpp v77, v66, v64 row_ror:8 row_mask:0xf bank_mask:0x2
    v_add_f32_dpp v79, v71, v69 row_ror:8 row_mask:0xf bank_mask:0x8
    v_add_f32_dpp v77, v70, v68 row_ror:8 row_mask:0xf bank_mask:0x4
    v_add_f32_dpp v79, v75, v73 row_ror:8 row_mask:0xf bank_mask:0x1
    v_add_f32_dpp v77, v74, v72 row_ror:8 row_mask:0xf bank_mask:0x8
    s_waitcnt vmcnt(6)
    s_cmp_eq_u32 s65, 2
    s_cbranch_scc1 L_go95
    s_waitcnt vmcnt(4)
    s_cmp_eq_u32 s65, 1
    s_cbranch_scc1 L_go95
    s_waitcnt vmcnt(3)
L_go95:
    buffer_load_dwordx4 v[156:159], v90, s[32:35], s48 offen offset:3072 nt
    s_add_u32 s48, s48, 0x20000
    s_bitset0_b32 s48, 21
    s_bitcmp1_b32 s51, 12
    s_cselect_b32 s65, 2, 1
    v_add_f32_dpp v76, v78, v76 row_ror:12 row_mask:0xf bank_mask:0xf
    v_add_f32_dpp v77, v79, v77 row_ror:12 row_mask:0xf bank_mask:0xf
    v_cvt_pk_bf16_f32 v78, v76, v77
    v_lshlrev_b32 v76, 16, v78
    v_and_b32 v77, 0xffff0000, v78
    v_mul_f32 v76, s44, v76
    v_mul_f32 v77, s44, v77
    v_cvt_pk_bf16_f32 v38, v76, v77
    v_lshlrev_b32 v76, 16, v38
    v_and_b32 v77, 0xffff0000, v38
    v_max3_f32 v82, v82, v76, v77
    v_mfma_f32_16x16x32_bf16 v[44:47], v[128:131], v[12:15], 0
    s_waitcnt vmcnt(6)
    s_cmp_eq_u32 s65, 2
    s_cbranch_scc1 L_go96
    s_waitcnt vmcnt(4)
    s_cmp_eq_u32 s65, 1
    s_cbranch_scc1 L_go96
    s_waitcnt vmcnt(3)
L_go96:
    buffer_load_dwordx4 v[160:163], v2, s[32:35], s48 offen offset:0 nt
    v_mfma_f32_16x16x32_bf16 v[48:51], v[132:135], v[16:19], 0
    s_waitcnt vmcnt(6)
    s_cmp_eq_u32 s65, 2
    s_cbranch_scc1 L_go97
    s_waitcnt vmcnt(4)
    s_cmp_eq_u32 s65, 1
    s_cbranch_scc1 L_go97
    s_waitcnt vmcnt(3)
L_go97:
    buffer_load_dwordx4 v[164:167], v2, s[32:35], s48 offen offset:1024 nt
    v_mfma_f32_16x16x32_bf16 v[52:55], v[136:139], v[20:23], 0
    s_waitcnt vmcnt(6)
    s_cmp_eq_u32 s65, 2
    s_cbranch_scc1 L_go98
    s_waitcnt vmcnt(4)
    s_cmp_eq_u32 s65, 1
    s_cbranch_scc1 L_go98
    s_waitcnt vmcnt(3)
L_go98:
    buffer_load_dwordx4 v[168:171], v2, s[32:35], s48 offen offset:2048 nt
    v_mfma_f32_16x16x32_bf16 v[56:59], v[140:143], v[24:27], 0
    s_waitcnt vmcnt(6)
    s_cmp_eq_u32 s65, 2
    s_cbranch_scc1 L_go99
    s_waitcnt vmcnt(4)
    s_cmp_eq_u32 s65, 1
    s_cbranch_scc1 L_go99
    s_waitcnt vmcnt(3)
L_go99:
    buffer_load_dwordx4 v[172:175], v2, s[32:35], s48 offen offset:3072 nt
    v_mfma_f32_16x16x32_bf16 v[60:63], v[144:147], v[12:15], 0
    s_waitcnt vmcnt(6)
    s_cmp_eq_u32 s65, 2
    s_cbranch_scc1 L_go100
    s_waitcnt vmcnt(4)
    s_cmp_eq_u32 s65, 1
    s_cbranch_scc1 L_go100
    s_waitcnt vmcnt(3)
L_go100:
    buffer_load_dwordx4 v[176:179], v90, s[32:35], s48 offen offset:0 nt
    v_mfma_f32_16x16x32_bf16 v[64:67], v[148:151], v[16:19], 0
    s_waitcnt vmcnt(6)
    s_cmp_eq_u32 s65, 2
    s_cbranch_scc1 L_go101
    s_waitcnt vmcnt(4)
    s_cmp_eq_u32 s65, 1
    s_cbranch_scc1 L_go101
    s_waitcnt vmcnt(3)
L_go101:
    buffer_load_dwordx4 v[180:183], v90, s[32:35], s48 offen offset:1024 nt
    v_mfma_f32_16x16x32_bf16 v[68:71], v[152:155], v[20:23], 0
    s_waitcnt vmcnt(6)
    s_cmp_eq_u32 s65, 2
    s_cbranch_scc1 L_go102
    s_waitcnt vmcnt(4)
    s_cmp_eq_u32 s65, 1
    s_cbranch_scc1 L_go102
    s_waitcnt vmcnt(3)
L_go102:
    buffer_load_dwordx4 v[184:187], v90, s[32:35], s48 offen offset:2048 nt
    v_mfma_f32_16x16x32_bf16 v[72:75], v[156:159], v[24:27], 0
    v_add_f32_dpp v78, v47, v45 row_ror:8 row_mask:0xf bank_mask:0x2
    v_add_f32_dpp v76, v46, v44 row_ror:8 row_mask:0xf bank_mask:0x1
    v_add_f32_dpp v78, v51, v49 row_ror:8 row_mask:0xf bank_mask:0x4
    v_add_f32_dpp v76, v50, v48 row_ror:8 row_mask:0xf bank_mask:0x2
    v_add_f32_dpp v78, v55, v53 row_ror:8 row_mask:0xf bank_mask:0x8
    v_add_f32_dpp v76, v54, v52 row_ror:8 row_mask:0xf bank_mask:0x4
    v_add_f32_dpp v78, v59, v57 row_ror:8 row_mask:0xf bank_mask:0x1
    v_add_f32_dpp v76, v58, v56 row_ror:8 row_mask:0xf bank_mask:0x8
    v_add_f32_dpp v79, v63, v61 row_ror:8 row_mask:0xf bank_mask:0x2
    v_add_f32_dpp v77, v62, v60 row_ror:8 row_mask:0xf bank_mask:0x1
    v_add_f32_dpp v79, v67, v65 row_ror:8 row_mask:0xf bank_mask:0x4
    v_add_f32_dpp v77, v66, v64 row_ror:8 row_mask:0xf bank_mask:0x2
    v_add_f32_dpp v79, v71, v69 row_ror:8 row_mask:0xf bank_mask:0x8
    v_add_f32_dpp v77, v70, v68 row_ror:8 row_mask:0xf bank_mask:0x4
    v_add_f32_dpp v79, v75, v73 row_ror:8 row_mask:0xf bank_mask:0x1
    v_add_f32_dpp v77, v74, v72 row_ror:8 row_mask:0xf bank_mask:0x8
    s_waitcnt vmcnt(6)
    s_cmp_eq_u32 s65, 2
    s_cbranch_scc1 L_go103
    s_waitcnt vmcnt(4)
    s_cmp_eq_u32 s65, 1
    s_cbranch_scc1 L_go103
    s_waitcnt vmcnt(3)
L_go103:
    buffer_load_dwordx4 v[188:191], v90, s[32:35], s48 offen offset:3072 nt
    s_add_u32 s48, s48, 0x20000
    s_bitset0_b32 s48, 21
    s_bitcmp1_b32 s51, 13
    s_cselect_b32 s65, 2, 1
    v_add_f32_dpp v76, v78, v76 row_ror:12 row_mask:0xf bank_mask:0xf
    v_add_f32_dpp v77, v79, v77 row_ror:12 row_mask:0xf bank_mask:0xf
    v_cvt_pk_bf16_f32 v78, v76, v77
    v_lshlrev_b32 v76, 16, v78
    v_and_b32 v77, 0xffff0000, v78
    v_mul_f32 v76, s44, v76
    v_mul_f32 v77, s44, v77
    v_cvt_pk_bf16_f32 v39, v76, v77
    v_lshlrev_b32 v76, 16, v39
    v_and_b32 v77, 0xffff0000, v39
    v_max3_f32 v82, v82, v76, v77
    v_mfma_f32_16x16x32_bf16 v[44:47], v[160:163], v[12:15], 0
    s_waitcnt vmcnt(6)
    s_cmp_eq_u32 s65, 2
    s_cbranch_scc1 L_go104
    s_waitcnt vmcnt(4)
    s_cmp_eq_u32 s65, 1
    s_cbranch_scc1 L_go104
    s_waitcnt vmcnt(3)
L_go104:
    buffer_load_dwordx4 v[192:195], v2, s[32:35], s48 offen offset:0 nt
    v_mfma_f32_16x16x32_bf16 v[48:51], v[164:167], v[16:19], 0
    s_waitcnt vmcnt(6)
    s_cmp_eq_u32 s65, 2
    s_cbranch_scc1 L_go105
    s_waitcnt vmcnt(4)
    s_cmp_eq_u32 s65, 1
    s_cbranch_scc1 L_go105
    s_waitcnt vmcnt(3)
L_go105:
    buffer_load_dwordx4 v[196:199], v2, s[32:35], s48 offen offset:1024 nt
    v_mfma_f32_16x16x32_bf16 v[52:55], v[168:171], v[20:23], 0
    s_waitcnt vmcnt(6)
    s_cmp_eq_u32 s65, 2
    s_cbranch_scc1 L_go106
    s_waitcnt vmcnt(4)
    s_cmp_eq_u32 s65, 1
    s_cbranch_scc1 L_go106
    s_waitcnt vmcnt(3)
L_go106:
    buffer_load_dwordx4 v[200:203], v2, s[32:35], s48 offen offset:2048 nt
    v_mfma_f32_16x16x32_bf16 v[56:59], v[172:175], v[24:27], 0
    s_waitcnt vmcnt(6)
    s_cmp_eq_u32 s65, 2
    s_cbranch_scc1 L_go107
    s_waitcnt vmcnt(4)
    s_cmp_eq_u32 s65, 1
    s_cbranch_scc1 L_go107
    s_waitcnt vmcnt(3)
L_go107:
    buffer_load_dwordx4 v[204:207], v2, s[32:35], s48 offen offset:3072 nt
    v_mfma_f32_16x16x32_bf16 v[60:63], v[176:179], v[12:15], 0
    s_waitcnt vmcnt(6)
    s_cmp_eq_u32 s65, 2
    s_cbranch_scc1 L_go108
    s_waitcnt vmcnt(4)
    s_cmp_eq_u32 s65, 1
    s_cbranch_scc1 L_go108
    s_waitcnt vmcnt(3)
L_go108:
    buffer_load_dwordx4 v[208:211], v90, s[32:35], s48 offen offset:0 nt
    v_mfma_f32_16x16x32_bf16 v[64:67], v[180:183], v[16:19], 0
    s_waitcnt vmcnt(6)
    s_cmp_eq_u32 s65, 2
    s_cbranch_scc1 L_go109
    s_waitcnt vmcnt(4)
    s_cmp_eq_u32 s65, 1
    s_cbranch_scc1 L_go109
    s_waitcnt vmcnt(3)
L_go109:
    buffer_load_dwordx4 v[212:215], v90, s[32:35], s48 offen offset:1024 nt
    v_mfma_f32_16x16x32_bf16 v[68:71], v[184:187], v[20:23], 0
    s_waitcnt vmcnt(6)
    s_cmp_eq_u32 s65, 2
    s_cbranch_scc1 L_go110
    s_waitcnt vmcnt(4)
    s_cmp_eq_u32 s65, 1
    s_cbranch_scc1 L_go110
    s_waitcnt vmcnt(3)
L_go110:
    buffer_load_dwordx4 v[216:219], v90, s[32:35], s48 offen offset:2048 nt
    v_mfma_f32_16x16x32_bf16 v[72:75], v[188:191], v[24:27], 0
    v_add_f32_dpp v78, v47, v45 row_ror:8 row_mask:0xf bank_mask:0x2
    v_add_f32_dpp v76, v46, v44 row_ror:8 row_mask:0xf bank_mask:0x1
    v_add_f32_dpp v78, v51, v49 row_ror:8 row_mask:0xf bank_mask:0x4
    v_add_f32_dpp v76, v50, v48 row_ror:8 row_mask:0xf bank_mask:0x2
    v_add_f32_dpp v78, v55, v53 row_ror:8 row_mask:0xf bank_mask:0x8
    v_add_f32_dpp v76, v54, v52 row_ror:8 row_mask:0xf bank_mask:0x4
    v_add_f32_dpp v78, v59, v57 row_ror:8 row_mask:0xf bank_mask:0x1
    v_add_f32_dpp v76, v58, v56 row_ror:8 row_mask:0xf bank_mask:0x8
    v_add_f32_dpp v79, v63, v61 row_ror:8 row_mask:0xf bank_mask:0x2
    v_add_f32_dpp v77, v62, v60 row_ror:8 row_mask:0xf bank_mask:0x1
    v_add_f32_dpp v79, v67, v65 row_ror:8 row_mask:0xf bank_mask:0x4
    v_add_f32_dpp v77, v66, v64 row_ror:8 row_mask:0xf bank_mask:0x2
    v_add_f32_dpp v79, v71, v69 row_ror:8 row_mask:0xf bank_mask:0x8
    v_add_f32_dpp v77, v70, v68 row_ror:8 row_mask:0xf bank_mask:0x4
    v_add_f32_dpp v79, v75, v73 row_ror:8 row_mask:0xf bank_mask:0x1
    v_add_f32_dpp v77, v74, v72 row_ror:8 row_mask:0xf bank_mask:0x8
    s_waitcnt vmcnt(6)
    s_cmp_eq_u32 s65, 2
    s_cbranch_scc1 L_go111
    s_waitcnt vmcnt(4)
    s_cmp_eq_u32 s65, 1
    s_cbranch_scc1 L_go111
    s_waitcnt vmcnt(3)
L_go111:
    buffer_load_dwordx4 v[220:223], v90, s[32:35], s48 offen offset:3072 nt
    s_add_u32 s48, s48, 0x20000
    s_bitset0_b32 s48, 21
    s_bitcmp1_b32 s51, 14
    s_cselect_b32 s65, 2, 1
    v_add_f32_dpp v76, v78, v76 row_ror:12 row_mask:0xf bank_mask:0xf
    v_add_f32_dpp v77, v79, v77 row_ror:12 row_mask:0xf bank_mask:0xf
    v_cvt_pk_bf16_f32 v78, v76, v77
    v_lshlrev_b32 v76, 16, v78
    v_and_b32 v77, 0xffff0000, v78
    v_mul_f32 v76, s44, v76
    v_mul_f32 v77, s44, v77
    v_cvt_pk_bf16_f32 v40, v76, v77
    v_lshlrev_b32 v76, 16, v40
    v_and_b32 v77, 0xffff0000, v40
    v_max3_f32 v82, v82, v76, v77
    v_mfma_f32_16x16x32_bf16 v[44:47], v[192:195], v[12:15], 0
    s_waitcnt vmcnt(6)
    s_cmp_eq_u32 s65, 2
    s_cbranch_scc1 L_go112
    s_waitcnt vmcnt(4)
    s_cmp_eq_u32 s65, 1
    s_cbranch_scc1 L_go112
    s_waitcnt vmcnt(3)
L_go112:
    buffer_load_dwordx4 v[224:227], v2, s[32:35], s48 offen offset:0 nt
    v_mfma_f32_16x16x32_bf16 v[48:51], v[196:199], v[16:19], 0
    s_waitcnt vmcnt(6)
    s_cmp_eq_u32 s65, 2
    s_cbranch_scc1 L_go113
    s_waitcnt vmcnt(4)
    s_cmp_eq_u32 s65, 1
    s_cbranch_scc1 L_go113
    s_waitcnt vmcnt(3)
L_go113:
    buffer_load_dwordx4 v[228:231], v2, s[32:35], s48 offen offset:1024 nt
    v_mfma_f32_16x16x32_bf16 v[52:55], v[200:203], v[20:23], 0
    s_waitcnt vmcnt(6)
    s_cmp_eq_u32 s65, 2
    s_cbranch_scc1 L_go114
    s_waitcnt vmcnt(4)
    s_cmp_eq_u32 s65, 1
    s_cbranch_scc1 L_go114
    s_waitcnt vmcnt(3)
L_go114:
    buffer_load_dwordx4 v[232:235], v2, s[32:35], s48 offen offset:2048 nt
    v_mfma_f32_16x16x32_bf16 v[56:59], v[204:207], v[24:27], 0
    s_waitcnt vmcnt(6)
    s_cmp_eq_u32 s65, 2
    s_cbranch_scc1 L_go115
    s_waitcnt vmcnt(4)
    s_cmp_eq_u32 s65, 1
    s_cbranch_scc1 L_go115
    s_waitcnt vmcnt(3)
L_go115:
    buffer_load_dwordx4 v[236:239], v2, s[32:35], s48 offen offset:3072 nt
    v_mfma_f32_16x16x32_bf16 v[60:63], v[208:211], v[12:15], 0
    s_waitcnt vmcnt(6)
    s_cmp_eq_u32 s65, 2
    s_cbranch_scc1 L_go116
    s_waitcnt vmcnt(4)
    s_cmp_eq_u32 s65, 1
    s_cbranch_scc1 L_go116
    s_waitcnt vmcnt(3)
L_go116:
    buffer_load_dwordx4 v[240:243], v90, s[32:35], s48 offen offset:0 nt
    v_mfma_f32_16x16x32_bf16 v[64:67], v[212:215], v[16:19], 0
    s_waitcnt vmcnt(6)
    s_cmp_eq_u32 s65, 2
    s_cbranch_scc1 L_go117
    s_waitcnt vmcnt(4)
    s_cmp_eq_u32 s65, 1
    s_cbranch_scc1 L_go117
    s_waitcnt vmcnt(3)
L_go117:
    buffer_load_dwordx4 v[244:247], v90, s[32:35], s48 offen offset:1024 nt
    v_mfma_f32_16x16x32_bf16 v[68:71], v[216:219], v[20:23], 0
    s_waitcnt vmcnt(6)
    s_cmp_eq_u32 s65, 2
    s_cbranch_scc1 L_go118
    s_waitcnt vmcnt(4)
    s_cmp_eq_u32 s65, 1
    s_cbranch_scc1 L_go118
    s_waitcnt vmcnt(3)
L_go118:
    buffer_load_dwordx4 v[248:251], v90, s[32:35], s48 offen offset:2048 nt
    v_mfma_f32_16x16x32_bf16 v[72:75], v[220:223], v[24:27], 0
    v_add_f32_dpp v78, v47, v45 row_ror:8 row_mask:0xf bank_mask:0x2
    v_add_f32_dpp v76, v46, v44 row_ror:8 row_mask:0xf bank_mask:0x1
    v_add_f32_dpp v78, v51, v49 row_ror:8 row_mask:0xf bank_mask:0x4
    v_add_f32_dpp v76, v50, v48 row_ror:8 row_mask:0xf bank_mask:0x2
    v_add_f32_dpp v78, v55, v53 row_ror:8 row_mask:0xf bank_mask:0x8
    v_add_f32_dpp v76, v54, v52 row_ror:8 row_mask:0xf bank_mask:0x4
    v_add_f32_dpp v78, v59, v57 row_ror:8 row_mask:0xf bank_mask:0x1
    v_add_f32_dpp v76, v58, v56 row_ror:8 row_mask:0xf bank_mask:0x8
    v_add_f32_dpp v79, v63, v61 row_ror:8 row_mask:0xf bank_mask:0x2
    v_add_f32_dpp v77, v62, v60 row_ror:8 row_mask:0xf bank_mask:0x1
    v_add_f32_dpp v79, v67, v65 row_ror:8 row_mask:0xf bank_mask:0x4
    v_add_f32_dpp v77, v66, v64 row_ror:8 row_mask:0xf bank_mask:0x2
    v_add_f32_dpp v79, v71, v69 row_ror:8 row_mask:0xf bank_mask:0x8
    v_add_f32_dpp v77, v70, v68 row_ror:8 row_mask:0xf bank_mask:0x4
    v_add_f32_dpp v79, v75, v73 row_ror:8 row_mask:0xf bank_mask:0x1
    v_add_f32_dpp v77, v74, v72 row_ror:8 row_mask:0xf bank_mask:0x8
    s_waitcnt vmcnt(6)
    s_cmp_eq_u32 s65, 2
    s_cbranch_scc1 L_go119
    s_waitcnt vmcnt(4)
    s_cmp_eq_u32 s65, 1
    s_cbranch_scc1 L_go119
    s_waitcnt vmcnt(3)
L_go119:
    buffer_load_dwordx4 v[252:255], v90, s[32:35], s48 offen offset:3072 nt
    s_add_u32 s48, s48, 0x20000
    s_bitset0_b32 s48, 21
    s_bitcmp1_b32 s51, 15
    s_cselect_b32 s65, 2, 1
    v_add_f32_dpp v76, v78, v76 row_ror:12 row_mask:0xf bank_mask:0xf
    v_add_f32_dpp v77, v79, v77 row_ror:12 row_mask:0xf bank_mask:0xf
    v_cvt_pk_bf16_f32 v78, v76, v77
    v_lshlrev_b32 v76, 16, v78
    v_and_b32 v77, 0xffff0000, v78
    v_mul_f32 v76, s44, v76
    v_mul_f32 v77, s44, v77
    v_cvt_pk_bf16_f32 v41, v76, v77
    v_lshlrev_b32 v76, 16, v41
    v_and_b32 v77, 0xffff0000, v41
    v_max3_f32 v82, v82, v76, v77
    v_mfma_f32_16x16x32_bf16 v[44:47], v[224:227], v[12:15], 0
    s_waitcnt vmcnt(6)
    s_cmp_eq_u32 s65, 2
    s_cbranch_scc1 L_go120
    s_waitcnt vmcnt(4)
    s_cmp_eq_u32 s65, 1
    s_cbranch_scc1 L_go120
    s_waitcnt vmcnt(3)
L_go120:
    buffer_load_dwordx4 v[96:99], v2, s[32:35], s48 offen offset:0 nt
    ds_add_u32 v94, v95 offset:20
    v_mfma_f32_16x16x32_bf16 v[48:51], v[228:231], v[16:19], 0
    s_waitcnt vmcnt(6)
    s_cmp_eq_u32 s65, 2
    s_cbranch_scc1 L_go121
    s_waitcnt vmcnt(4)
    s_cmp_eq_u32 s65, 1
    s_cbranch_scc1 L_go121
    s_waitcnt vmcnt(3)
L_go121:
    buffer_load_dwordx4 v[100:103], v2, s[32:35], s48 offen offset:1024 nt
    v_mfma_f32_16x16x32_bf16 v[52:55], v[232:235], v[20:23], 0
    s_waitcnt vmcnt(6)
    s_cmp_eq_u32 s65, 2
    s_cbranch_scc1 L_go122
    s_waitcnt vmcnt(4)
    s_cmp_eq_u32 s65, 1
    s_cbranch_scc1 L_go122
    s_waitcnt vmcnt(3)
L_go122:
    buffer_load_dwordx4 v[104:107], v2, s[32:35], s48 offen offset:2048 nt
    v_mfma_f32_16x16x32_bf16 v[56:59], v[236:239], v[24:27], 0
    s_waitcnt vmcnt(6)
    s_cmp_eq_u32 s65, 2
    s_cbranch_scc1 L_go123
    s_waitcnt vmcnt(4)
    s_cmp_eq_u32 s65, 1
    s_cbranch_scc1 L_go123
    s_waitcnt vmcnt(3)
L_go123:
    buffer_load_dwordx4 v[108:111], v2, s[32:35], s48 offen offset:3072 nt
    s_waitcnt lgkmcnt(0)
    v_readfirstlane_b32 s66, v80
    v_readfirstlane_b32 s67, v81
    ds_read_b64 v[80:81], v94 offset:24
    s_bitcmp1_b32 s51, 15
    s_cselect_b32 s65, 2, 1
    s_cmpk_gt_i32 s66, 125
    s_cselect_b32 s65, 2, s65
    s_cmpk_gt_i32 s67, 125
    s_cselect_b32 s65, 0, s65
    v_mfma_f32_16x16x32_bf16 v[60:63], v[240:243], v[12:15], 0
    s_waitcnt vmcnt(6)
    s_cmp_eq_u32 s65, 2
    s_cbranch_scc1 L_go124
    s_waitcnt vmcnt(4)
    s_cmp_eq_u32 s65, 1
    s_cbranch_scc1 L_go124
    s_waitcnt vmcnt(3)
L_go124:
    buffer_load_dwordx4 v[112:115], v90, s[32:35], s48 offen offset:0 nt
    v_mfma_f32_16x16x32_bf16 v[64:67], v[244:247], v[16:19], 0
    s_waitcnt vmcnt(6)
    s_cmp_eq_u32 s65, 2
    s_cbranch_scc1 L_go125
    s_waitcnt vmcnt(4)
    s_cmp_eq_u32 s65, 1
    s_cbranch_scc1 L_go125
    s_waitcnt vmcnt(3)
L_go125:
    buffer_load_dwordx4 v[116:119], v90, s[32:35], s48 offen offset:1024 nt
    v_mfma_f32_16x16x32_bf16 v[68:71], v[248:251], v[20:23], 0
    s_waitcnt vmcnt(6)
    s_cmp_eq_u32 s65, 2
    s_cbranch_scc1 L_go126
    s_waitcnt vmcnt(4)
    s_cmp_eq_u32 s65, 1
    s_cbranch_scc1 L_go126
    s_waitcnt vmcnt(3)
L_go126:
    buffer_load_dwordx4 v[120:123], v90, s[32:35], s48 offen offset:2048 nt
    v_mfma_f32_16x16x32_bf16 v[72:75], v[252:255], v[24:27], 0
    v_add_f32_dpp v78, v47, v45 row_ror:8 row_mask:0xf bank_mask:0x2
    v_add_f32_dpp v76, v46, v44 row_ror:8 row_mask:0xf bank_mask:0x1
    v_add_f32_dpp v78, v51, v49 row_ror:8 row_mask:0xf bank_mask:0x4
    v_add_f32_dpp v76, v50, v48 row_ror:8 row_mask:0xf bank_mask:0x2
    v_add_f32_dpp v78, v55, v53 row_ror:8 row_mask:0xf bank_mask:0x8
    v_add_f32_dpp v76, v54, v52 row_ror:8 row_mask:0xf bank_mask:0x4
    v_add_f32_dpp v78, v59, v57 row_ror:8 row_mask:0xf bank_mask:0x1
    v_add_f32_dpp v76, v58, v56 row_ror:8 row_mask:0xf bank_mask:0x8
    v_add_f32_dpp v79, v63, v61 row_ror:8 row_mask:0xf bank_mask:0x2
    v_add_f32_dpp v77, v62, v60 row_ror:8 row_mask:0xf bank_mask:0x1
    v_add_f32_dpp v79, v67, v65 row_ror:8 row_mask:0xf bank_mask:0x4
    v_add_f32_dpp v77, v66, v64 row_ror:8 row_mask:0xf bank_mask:0x2
    v_add_f32_dpp v79, v71, v69 row_ror:8 row_mask:0xf bank_mask:0x8
    v_add_f32_dpp v77, v70, v68 row_ror:8 row_mask:0xf bank_mask:0x4
    v_add_f32_dpp v79, v75, v73 row_ror:8 row_mask:0xf bank_mask:0x1
    v_add_f32_dpp v77, v74, v72 row_ror:8 row_mask:0xf bank_mask:0x8
    s_waitcnt vmcnt(6)
    s_cmp_eq_u32 s65, 2
    s_cbranch_scc1 L_go127
    s_waitcnt vmcnt(4)
    s_cmp_eq_u32 s65, 1
    s_cbranch_scc1 L_go127
    s_waitcnt vmcnt(3)
L_go127:
    buffer_load_dwordx4 v[124:127], v90, s[32:35], s48 offen offset:3072 nt
    s_add_u32 s48, s48, 0x20000
    s_bitset0_b32 s48, 21
    s_waitcnt lgkmcnt(0)
    v_readfirstlane_b32 s66, v80
    v_readfirstlane_b32 s67, v81
    ds_read_b64 v[80:81], v94 offset:24
    s_bitcmp1_b32 s51, 16
    s_cselect_b32 s65, 2, 1
    s_cmpk_gt_i32 s66, 129
    s_cselect_b32 s65, 2, s65
    s_cmpk_gt_i32 s67, 129
    s_cselect_b32 s65, 0, s65
    v_add_f32_dpp v76, v78, v76 row_ror:12 row_mask:0xf bank_mask:0xf
    v_add_f32_dpp v77, v79, v77 row_ror:12 row_mask:0xf bank_mask:0xf
    v_cvt_pk_bf16_f32 v78, v76, v77
    v_lshlrev_b32 v76, 16, v78
    v_and_b32 v77, 0xffff0000, v78
    v_mul_f32 v76, s44, v76
    v_mul_f32 v77, s44, v77
    v_cvt_pk_bf16_f32 v42, v76, v77
    v_lshlrev_b32 v76, 16, v42
    v_and_b32 v77, 0xffff0000, v42
    v_max3_f32 v82, v82, v76, v77
    v_mfma_f32_16x16x32_bf16 v[44:47], v[96:99], v[12:15], 0
    s_waitcnt vmcnt(6)
    s_cmp_eq_u32 s65, 2
    s_cbranch_scc1 L_go128
    s_waitcnt vmcnt(4)
    s_cmp_eq_u32 s65, 1
    s_cbranch_scc1 L_go128
    s_waitcnt vmcnt(3)
L_go128:
    buffer_load_dwordx4 v[128:131], v0, s[36:39], s48 offen offset:0 nt
    v_mfma_f32_16x16x32_bf16 v[48:51], v[100:103], v[16:19], 0
    s_waitcnt vmcnt(6)
    s_cmp_eq_u32 s65, 2
    s_cbranch_scc1 L_go129
    s_waitcnt vmcnt(4)
    s_cmp_eq_u32 s65, 1
    s_cbranch_scc1 L_go129
    s_waitcnt vmcnt(3)
L_go129:
    buffer_load_dwordx4 v[132:135], v0, s[36:39], s48 offen offset:1024 nt
    v_mfma_f32_16x16x32_bf16 v[52:55], v[104:107], v[20:23], 0
    s_waitcnt vmcnt(6)
    s_cmp_eq_u32 s65, 2
    s_cbranch_scc1 L_go130
    s_waitcnt vmcnt(4)
    s_cmp_eq_u32 s65, 1
    s_cbranch_scc1 L_go130
    s_waitcnt vmcnt(3)
L_go130:
    buffer_load_dwordx4 v[136:139], v0, s[36:39], s48 offen offset:2048 nt
    v_mfma_f32_16x16x32_bf16 v[56:59], v[108:111], v[24:27], 0
    s_waitcnt vmcnt(6)
    s_cmp_eq_u32 s65, 2
    s_cbranch_scc1 L_go131
    s_waitcnt vmcnt(4)
    s_cmp_eq_u32 s65, 1
    s_cbranch_scc1 L_go131
    s_waitcnt vmcnt(3)
L_go131:
    buffer_load_dwordx4 v[140:143], v0, s[36:39], s48 offen offset:3072 nt
    s_waitcnt lgkmcnt(0)
    v_readfirstlane_b32 s66, v80
    v_readfirstlane_b32 s67, v81
    ds_read_b64 v[80:81], v94 offset:24
    s_bitcmp1_b32 s51, 16
    s_cselect_b32 s65, 2, 1
    s_cmpk_gt_i32 s66, 133
    s_cselect_b32 s65, 2, s65
    s_cmpk_gt_i32 s67, 133
    s_cselect_b32 s65, 0, s65
    v_mfma_f32_16x16x32_bf16 v[60:63], v[112:115], v[12:15], 0
    s_waitcnt vmcnt(6)
    s_cmp_eq_u32 s65, 2
    s_cbranch_scc1 L_go132
    s_waitcnt vmcnt(4)
    s_cmp_eq_u32 s65, 1
    s_cbranch_scc1 L_go132
    s_waitcnt vmcnt(3)
L_go132:
    buffer_load_dwordx4 v[144:147], v91, s[36:39], s48 offen offset:0 nt
    v_mfma_f32_16x16x32_bf16 v[64:67], v[116:119], v[16:19], 0
    s_waitcnt vmcnt(6)
    s_cmp_eq_u32 s65, 2
    s_cbranch_scc1 L_go133
    s_waitcnt vmcnt(4)
    s_cmp_eq_u32 s65, 1
    s_cbranch_scc1 L_go133
    s_waitcnt vmcnt(3)
L_go133:
    buffer_load_dwordx4 v[148:151], v91, s[36:39], s48 offen offset:1024 nt
    v_mfma_f32_16x16x32_bf16 v[68:71], v[120:123], v[20:23], 0
    s_waitcnt vmcnt(6)
    s_cmp_eq_u32 s65, 2
    s_cbranch_scc1 L_go134
    s_waitcnt vmcnt(4)
    s_cmp_eq_u32 s65, 1
    s_cbranch_scc1 L_go134
    s_waitcnt vmcnt(3)
L_go134:
    buffer_load_dwordx4 v[152:155], v91, s[36:39], s48 offen offset:2048 nt
    v_mfma_f32_16x16x32_bf16 v[72:75], v[124:127], v[24:27], 0
    v_add_f32_dpp v78, v47, v45 row_ror:8 row_mask:0xf bank_mask:0x2
    v_add_f32_dpp v76, v46, v44 row_ror:8 row_mask:0xf bank_mask:0x1
    v_add_f32_dpp v78, v51, v49 row_ror:8 row_mask:0xf bank_mask:0x4
    v_add_f32_dpp v76, v50, v48 row_ror:8 row_mask:0xf bank_mask:0x2
    v_add_f32_dpp v78, v55, v53 row_ror:8 row_mask:0xf bank_mask:0x8
    v_add_f32_dpp v76, v54, v52 row_ror:8 row_mask:0xf bank_mask:0x4
    v_add_f32_dpp v78, v59, v57 row_ror:8 row_mask:0xf bank_mask:0x1
    v_add_f32_dpp v76, v58, v56 row_ror:8 row_mask:0xf bank_mask:0x8
    v_add_f32_dpp v79, v63, v61 row_ror:8 row_mask:0xf bank_mask:0x2
    v_add_f32_dpp v77, v62, v60 row_ror:8 row_mask:0xf bank_mask:0x1
    v_add_f32_dpp v79, v67, v65 row_ror:8 row_mask:0xf bank_mask:0x4
    v_add_f32_dpp v77, v66, v64 row_ror:8 row_mask:0xf bank_mask:0x2
    v_add_f32_dpp v79, v71, v69 row_ror:8 row_mask:0xf bank_mask:0x8
    v_add_f32_dpp v77, v70, v68 row_ror:8 row_mask:0xf bank_mask:0x4
    v_add_f32_dpp v79, v75, v73 row_ror:8 row_mask:0xf bank_mask:0x1
    v_add_f32_dpp v77, v74, v72 row_ror:8 row_mask:0xf bank_mask:0x8
    s_waitcnt vmcnt(6)
    s_cmp_eq_u32 s65, 2
    s_cbranch_scc1 L_go135
    s_waitcnt vmcnt(4)
    s_cmp_eq_u32 s65, 1
    s_cbranch_scc1 L_go135
    s_waitcnt vmcnt(3)
L_go135:
    buffer_load_dwordx4 v[156:159], v91, s[36:39], s48 offen offset:3072 nt
    s_add_u32 s48, s48, 0x20000
    s_bitset0_b32 s48, 21
    s_waitcnt lgkmcnt(0)
    v_readfirstlane_b32 s66, v80
    v_readfirstlane_b32 s67, v81
    ds_read_b64 v[80:81], v94 offset:24
    s_bitcmp1_b32 s51, 17
    s_cselect_b32 s65, 2, 1
    s_cmpk_gt_i32 s66, 137
    s_cselect_b32 s65, 2, s65
    s_cmpk_gt_i32 s67, 137
    s_cselect_b32 s65, 0, s65
    v_add_f32_dpp v76, v78, v76 row_ror:12 row_mask:0xf bank_mask:0xf
    v_add_f32_dpp v77, v79, v77 row_ror:12 row_mask:0xf bank_mask:0xf
    v_cvt_pk_bf16_f32 v78, v76, v77
    v_lshlrev_b32 v76, 16, v78
    v_and_b32 v77, 0xffff0000, v78
    v_mul_f32 v76, s44, v76
    v_mul_f32 v77, s44, v77
    v_cvt_pk_bf16_f32 v43, v76, v77
    v_lshlrev_b32 v76, 16, v43
    v_and_b32 v77, 0xffff0000, v43
    v_max3_f32 v82, v82, v76, v77
    s_waitcnt vmcnt(6)
    s_cmp_eq_u32 s65, 2
    s_cbranch_scc1 L_go136
    s_waitcnt vmcnt(4)
    s_cmp_eq_u32 s65, 1
    s_cbranch_scc1 L_go136
    s_waitcnt vmcnt(3)
L_go136:
    buffer_load_dwordx4 v[160:163], v0, s[36:39], s48 offen offset:0 nt
    v_max_f32_dpp v82, v82, v82 row_ror:8 row_mask:0xf bank_mask:0xf
    s_nop 1
    v_max_f32_dpp v82, v82, v82 row_ror:4 row_mask:0xf bank_mask:0xf
    v_mov_b32 v85, v82
    s_nop 1
    v_permlane16_swap_b32 v85, v82
    v_max_f32 v82, v85, v82
    v_mov_b32 v85, v82
    s_nop 1
    v_permlane32_swap_b32 v85, v82
    v_max_f32 v82, v85, v82
    v_mul_f32 v82, s45, v82
    s_waitcnt vmcnt(6)
    s_cmp_eq_u32 s65, 2
    s_cbranch_scc1 L_go137
    s_waitcnt vmcnt(4)
    s_cmp_eq_u32 s65, 1
    s_cbranch_scc1 L_go137
    s_waitcnt vmcnt(3)
L_go137:
    buffer_load_dwordx4 v[164:167], v0, s[36:39], s48 offen offset:1024 nt
    v_mov_b32 v12, 0
    v_mov_b32 v13, 0
    v_mov_b32 v14, 0
    v_mov_b32 v15, 0
    v_mov_b32 v16, 0
    v_mov_b32 v17, 0
    v_mov_b32 v18, 0
    v_mov_b32 v19, 0
    v_mov_b32 v20, 0
    v_mov_b32 v21, 0
    v_mov_b32 v22, 0
    v_mov_b32 v23, 0
    v_mov_b32 v24, 0
    v_mov_b32 v25, 0
    v_mov_b32 v26, 0
    v_mov_b32 v27, 0
    s_waitcnt vmcnt(6)
    s_cmp_eq_u32 s65, 2
    s_cbranch_scc1 L_go138
    s_waitcnt vmcnt(4)
    s_cmp_eq_u32 s65, 1
    s_cbranch_scc1 L_go138
    s_waitcnt vmcnt(3)
L_go138:
    buffer_load_dwordx4 v[168:171], v0, s[36:39], s48 offen offset:2048 nt
    v_lshlrev_b32 v76, 16, v28
    v_and_b32 v77, 0xffff0000, v28
    v_lshlrev_b32 v78, 16, v29
    v_and_b32 v79, 0xffff0000, v29
    v_fma_f32 v76, v76, s45, -v82
    v_fma_f32 v77, v77, s45, -v82
    v_fma_f32 v78, v78, s45, -v82
    v_fma_f32 v79, v79, s45, -v82
    v_exp_f32 v76, v76
    v_exp_f32 v77, v77
    v_exp_f32 v78, v78
    v_exp_f32 v79, v79
    v_add_f32 v84, v76, v77
    v_cvt_pk_bf16_f32 v28, v76, v77
    v_add_f32 v85, v78, v79
    v_cvt_pk_bf16_f32 v29, v78, v79
    v_add_f32 v83, v84, v85
    s_waitcnt vmcnt(6)
    s_cmp_eq_u32 s65, 2
    s_cbranch_scc1 L_go139
    s_waitcnt vmcnt(4)
    s_cmp_eq_u32 s65, 1
    s_cbranch_scc1 L_go139
    s_waitcnt vmcnt(3)
L_go139:
    buffer_load_dwordx4 v[172:175], v0, s[36:39], s48 offen offset:3072 nt
    s_waitcnt lgkmcnt(0)
    v_readfirstlane_b32 s66, v80
    v_readfirstlane_b32 s67, v81
    ds_read_b64 v[80:81], v94 offset:24
    s_bitcmp1_b32 s51, 17
    s_cselect_b32 s65, 2, 1
    s_cmpk_gt_i32 s66, 141
    s_cselect_b32 s65, 2, s65
    s_cmpk_gt_i32 s67, 141
    s_cselect_b32 s65, 0, s65
    v_lshlrev_b32 v76, 16, v30
    v_and_b32 v77, 0xffff0000, v30
    v_lshlrev_b32 v78, 16, v31
    v_and_b32 v79, 0xffff0000, v31
    v_fma_f32 v76, v76, s45, -v82
    v_fma_f32 v77, v77, s45, -v82
    v_fma_f32 v78, v78, s45, -v82
    v_fma_f32 v79, v79, s45, -v82
    v_exp_f32 v76, v76
    v_exp_f32 v77, v77
    v_exp_f32 v78, v78
    v_exp_f32 v79, v79
    v_add_f32 v84, v76, v77
    v_cvt_pk_bf16_f32 v30, v76, v77
    v_add_f32 v85, v78, v79
    v_cvt_pk_bf16_f32 v31, v78, v79
    v_add_f32 v84, v84, v85
    v_add_f32 v83, v83, v84
    s_waitcnt vmcnt(6)
    s_cmp_eq_u32 s65, 2
    s_cbranch_scc1 L_go140
    s_waitcnt vmcnt(4)
    s_cmp_eq_u32 s65, 1
    s_cbranch_scc1 L_go140
    s_waitcnt vmcnt(3)
L_go140:
    buffer_load_dwordx4 v[176:179], v91, s[36:39], s48 offen offset:0 nt
    v_lshlrev_b32 v76, 16, v32
    v_and_b32 v77, 0xffff0000, v32
    v_lshlrev_b32 v78, 16, v33
    v_and_b32 v79, 0xffff0000, v33
    v_fma_f32 v76, v76, s45, -v82
    v_fma_f32 v77, v77, s45, -v82
    v_fma_f32 v78, v78, s45, -v82
    v_fma_f32 v79, v79, s45, -v82
    v_exp_f32 v76, v76
    v_exp_f32 v77, v77
    v_exp_f32 v78, v78
    v_exp_f32 v79, v79
    v_add_f32 v84, v76, v77
    v_cvt_pk_bf16_f32 v32, v76, v77
    v_add_f32 v85, v78, v79
    v_cvt_pk_bf16_f32 v33, v78, v79
    v_add_f32 v84, v84, v85
    v_add_f32 v83, v83, v84
    s_waitcnt vmcnt(6)
    s_cmp_eq_u32 s65, 2
    s_cbranch_scc1 L_go141
    s_waitcnt vmcnt(4)
    s_cmp_eq_u32 s65, 1
    s_cbranch_scc1 L_go141
    s_waitcnt vmcnt(3)
L_go141:
    buffer_load_dwordx4 v[180:183], v91, s[36:39], s48 offen offset:1024 nt
    v_lshlrev_b32 v76, 16, v34
    v_and_b32 v77, 0xffff0000, v34
    v_lshlrev_b32 v78, 16, v35
    v_and_b32 v79, 0xffff0000, v35
    v_fma_f32 v76, v76, s45, -v82
    v_fma_f32 v77, v77, s45, -v82
    v_fma_f32 v78, v78, s45, -v82
    v_fma_f32 v79, v79, s45, -v82
    v_exp_f32 v76, v76
    v_exp_f32 v77, v77
    v_exp_f32 v78, v78
    v_exp_f32 v79, v79
    v_add_f32 v84, v76, v77
    v_cvt_pk_bf16_f32 v34, v76, v77
    v_add_f32 v85, v78, v79
    v_cvt_pk_bf16_f32 v35, v78, v79
    v_add_f32 v84, v84, v85
    v_add_f32 v83, v83, v84
    s_waitcnt vmcnt(6)
    s_cmp_eq_u32 s65, 2
    s_cbranch_scc1 L_go142
    s_waitcnt vmcnt(4)
    s_cmp_eq_u32 s65, 1
    s_cbranch_scc1 L_go142
    s_waitcnt vmcnt(3)
L_go142:
    buffer_load_dwordx4 v[184:187], v91, s[36:39], s48 offen offset:2048 nt
    v_lshlrev_b32 v76, 16, v36
    v_and_b32 v77, 0xffff0000, v36
    v_lshlrev_b32 v78, 16, v37
    v_and_b32 v79, 0xffff0000, v37
    v_fma_f32 v76, v76, s45, -v82
    v_fma_f32 v77, v77, s45, -v82
    v_fma_f32 v78, v78, s45, -v82
    v_fma_f32 v79, v79, s45, -v82
    v_exp_f32 v76, v76
    v_exp_f32 v77, v77
    v_exp_f32 v78, v78
    v_exp_f32 v79, v79
    v_add_f32 v84, v76, v77
    v_cvt_pk_bf16_f32 v36, v76, v77
    v_add_f32 v85, v78, v79
    v_cvt_pk_bf16_f32 v37, v78, v79
    v_add_f32 v84, v84, v85
    v_add_f32 v83, v83, v84
    s_waitcnt vmcnt(6)
    s_cmp_eq_u32 s65, 2
    s_cbranch_scc1 L_go143
    s_waitcnt vmcnt(4)
    s_cmp_eq_u32 s65, 1
    s_cbranch_scc1 L_go143
    s_waitcnt vmcnt(3)
L_go143:
    buffer_load_dwordx4 v[188:191], v91, s[36:39], s48 offen offset:3072 nt
    s_add_u32 s48, s48, 0x20000
    s_bitset0_b32 s48, 21
    s_waitcnt lgkmcnt(0)
    v_readfirstlane_b32 s66, v80
    v_readfirstlane_b32 s67, v81
    ds_read_b64 v[80:81], v94 offset:24
    s_bitcmp1_b32 s51, 18
    s_cselect_b32 s65, 2, 1
    s_cmpk_gt_i32 s66, 145
    s_cselect_b32 s65, 2, s65
    s_cmpk_gt_i32 s67, 145
    s_cselect_b32 s65, 0, s65
    v_lshlrev_b32 v76, 16, v38
    v_and_b32 v77, 0xffff0000, v38
    v_lshlrev_b32 v78, 16, v39
    v_and_b32 v79, 0xffff0000, v39
    v_fma_f32 v76, v76, s45, -v82
    v_fma_f32 v77, v77, s45, -v82
    v_fma_f32 v78, v78, s45, -v82
    v_fma_f32 v79, v79, s45, -v82
    v_exp_f32 v76, v76
    v_exp_f32 v77, v77
    v_exp_f32 v78, v78
    v_exp_f32 v79, v79
    v_add_f32 v84, v76, v77
    v_cvt_pk_bf16_f32 v38, v76, v77
    v_add_f32 v85, v78, v79
    v_cvt_pk_bf16_f32 v39, v78, v79
    v_add_f32 v84, v84, v85
    v_add_f32 v83, v83, v84
    s_waitcnt vmcnt(6)
    s_cmp_eq_u32 s65, 2
    s_cbranch_scc1 L_go144
    s_waitcnt vmcnt(4)
    s_cmp_eq_u32 s65, 1
    s_cbranch_scc1 L_go144
    s_waitcnt vmcnt(3)
L_go144:
    buffer_load_dwordx4 v[192:195], v0, s[36:39], s48 offen offset:0 nt
    v_lshlrev_b32 v76, 16, v40
    v_and_b32 v77, 0xffff0000, v40
    v_lshlrev_b32 v78, 16, v41
    v_and_b32 v79, 0xffff0000, v41
    v_fma_f32 v76, v76, s45, -v82
    v_fma_f32 v77, v77, s45, -v82
    v_fma_f32 v78, v78, s45, -v82
    v_fma_f32 v79, v79, s45, -v82
    v_exp_f32 v76, v76
    v_exp_f32 v77, v77
    v_exp_f32 v78, v78
    v_exp_f32 v79, v79
    v_add_f32 v84, v76, v77
    v_cvt_pk_bf16_f32 v40, v76, v77
    v_add_f32 v85, v78, v79
    v_cvt_pk_bf16_f32 v41, v78, v79
    v_add_f32 v84, v84, v85
    v_add_f32 v83, v83, v84
    s_waitcnt vmcnt(6)
    s_cmp_eq_u32 s65, 2
    s_cbranch_scc1 L_go145
    s_waitcnt vmcnt(4)
    s_cmp_eq_u32 s65, 1
    s_cbranch_scc1 L_go145
    s_waitcnt vmcnt(3)
L_go145:
    buffer_load_dwordx4 v[196:199], v0, s[36:39], s48 offen offset:1024 nt
    v_lshlrev_b32 v76, 16, v42
    v_and_b32 v77, 0xffff0000, v42
    v_lshlrev_b32 v78, 16, v43
    v_and_b32 v79, 0xffff0000, v43
    v_fma_f32 v76, v76, s45, -v82
    v_fma_f32 v77, v77, s45, -v82
    v_fma_f32 v78, v78, s45, -v82
    v_fma_f32 v79, v79, s45, -v82
    v_exp_f32 v76, v76
    v_exp_f32 v77, v77
    v_exp_f32 v78, v78
    v_exp_f32 v79, v79
    v_add_f32 v84, v76, v77
    v_cvt_pk_bf16_f32 v42, v76, v77
    v_add_f32 v85, v78, v79
    v_cvt_pk_bf16_f32 v43, v78, v79
    v_add_f32 v84, v84, v85
    v_add_f32 v83, v83, v84
    s_waitcnt vmcnt(6)
    s_cmp_eq_u32 s65, 2
    s_cbranch_scc1 L_go146
    s_waitcnt vmcnt(4)
    s_cmp_eq_u32 s65, 1
    s_cbranch_scc1 L_go146
    s_waitcnt vmcnt(3)
L_go146:
    buffer_load_dwordx4 v[200:203], v0, s[36:39], s48 offen offset:2048 nt
    v_add_f32_dpp v83, v83, v83 row_ror:8 row_mask:0xf bank_mask:0xf
    s_nop 1
    v_add_f32_dpp v83, v83, v83 row_ror:4 row_mask:0xf bank_mask:0xf
    v_mov_b32 v85, v83
    s_nop 1
    v_permlane16_swap_b32 v85, v83
    v_add_f32 v83, v85, v83
    v_mov_b32 v85, v83
    s_nop 1
    v_permlane32_swap_b32 v85, v83
    v_add_f32 v83, v85, v83
    ds_write_b64 v88, v[82:83]
    v_mov_b32 v84, 79076
    v_mov_b32 v85, 1
    s_mov_b64 exec, 1
    ds_add_u32 v84, v85
    s_mov_b64 exec, -1
    s_waitcnt vmcnt(6)
    s_cmp_eq_u32 s65, 2
    s_cbranch_scc1 L_go147
    s_waitcnt vmcnt(4)
    s_cmp_eq_u32 s65, 1
    s_cbranch_scc1 L_go147
    s_waitcnt vmcnt(3)
L_go147:
    buffer_load_dwordx4 v[204:207], v0, s[36:39], s48 offen offset:3072 nt
    s_waitcnt lgkmcnt(0)
    v_readfirstlane_b32 s66, v80
    v_readfirstlane_b32 s67, v81
    ds_read_b64 v[80:81], v94 offset:24
    s_bitcmp1_b32 s51, 18
    s_cselect_b32 s65, 2, 1
    s_cmpk_gt_i32 s66, 149
    s_cselect_b32 s65, 2, s65
    s_cmpk_gt_i32 s67, 149
    s_cselect_b32 s65, 0, s65
    v_mov_b32_dpp v78, v28 row_ror:12 row_mask:0xf bank_mask:0xf
    v_perm_b32 v76, v78, v28, s46
    v_perm_b32 v77, v78, v28, s47
    s_nop 0
    v_mov_b32_dpp v12, v76 quad_perm:[0,1,2,3] row_mask:0xf bank_mask:0x1
    v_mov_b32_dpp v13, v76 row_ror:8 row_mask:0xf bank_mask:0x1
    v_mov_b32_dpp v14, v77 quad_perm:[0,1,2,3] row_mask:0xf bank_mask:0x1
    v_mov_b32_dpp v15, v77 row_ror:8 row_mask:0xf bank_mask:0x1
    v_mov_b32_dpp v16, v76 quad_perm:[0,1,2,3] row_mask:0xf bank_mask:0x2
    v_mov_b32_dpp v17, v76 row_ror:8 row_mask:0xf bank_mask:0x2
    v_mov_b32_dpp v18, v77 quad_perm:[0,1,2,3] row_mask:0xf bank_mask:0x2
    v_mov_b32_dpp v19, v77 row_ror:8 row_mask:0xf bank_mask:0x2
    s_waitcnt vmcnt(6)
    s_cmp_eq_u32 s65, 2
    s_cbranch_scc1 L_go148
    s_waitcnt vmcnt(4)
    s_cmp_eq_u32 s65, 1
    s_cbranch_scc1 L_go148
    s_waitcnt vmcnt(3)
L_go148:
    buffer_load_dwordx4 v[208:211], v91, s[36:39], s48 offen offset:0 nt
    v_mov_b32_dpp v20, v76 quad_perm:[0,1,2,3] row_mask:0xf bank_mask:0x4
    v_mov_b32_dpp v21, v76 row_ror:8 row_mask:0xf bank_mask:0x4
    v_mov_b32_dpp v22, v77 quad_perm:[0,1,2,3] row_mask:0xf bank_mask:0x4
    v_mov_b32_dpp v23, v77 row_ror:8 row_mask:0xf bank_mask:0x4
    v_mov_b32_dpp v24, v76 quad_perm:[0,1,2,3] row_mask:0xf bank_mask:0x8
    v_mov_b32_dpp v25, v76 row_ror:8 row_mask:0xf bank_mask:0x8
    v_mov_b32_dpp v26, v77 quad_perm:[0,1,2,3] row_mask:0xf bank_mask:0x8
    v_mov_b32_dpp v27, v77 row_ror:8 row_mask:0xf bank_mask:0x8
    v_perm_b32 v44, v132, v128, s46
    v_perm_b32 v45, v140, v136, s46
    v_perm_b32 v48, v136, v132, s47
    v_perm_b32 v49, v128, v140, s47
    v_perm_b32 v52, v141, v137, s46
    v_perm_b32 v53, v133, v129, s46
    v_perm_b32 v56, v129, v141, s47
    v_perm_b32 v57, v137, v133, s47
    s_waitcnt vmcnt(6)
    s_cmp_eq_u32 s65, 2
    s_cbranch_scc1 L_go149
    s_waitcnt vmcnt(4)
    s_cmp_eq_u32 s65, 1
    s_cbranch_scc1 L_go149
    s_waitcnt vmcnt(3)
L_go149:
    buffer_load_dwordx4 v[212:215], v91, s[36:39], s48 offen offset:1024 nt
    v_perm_b32 v60, v134, v130, s46
    v_perm_b32 v61, v142, v138, s46
    v_perm_b32 v64, v138, v134, s47
    v_perm_b32 v65, v130, v142, s47
    v_perm_b32 v68, v143, v139, s46
    v_perm_b32 v69, v135, v131, s46
    v_perm_b32 v72, v131, v143, s47
    v_perm_b32 v73, v139, v135, s47
    s_waitcnt vmcnt(6)
    s_cmp_eq_u32 s65, 2
    s_cbranch_scc1 L_go150
    s_waitcnt vmcnt(4)
    s_cmp_eq_u32 s65, 1
    s_cbranch_scc1 L_go150
    s_waitcnt vmcnt(3)
L_go150:
    buffer_load_dwordx4 v[216:219], v91, s[36:39], s48 offen offset:2048 nt
    v_perm_b32 v46, v148, v144, s46
    v_perm_b32 v47, v156, v152, s46
    v_perm_b32 v62, v150, v146, s46
    v_perm_b32 v63, v158, v154, s46
    v_mfma_f32_16x16x32_bf16 v[4:7], v[44:47], v[12:15], 0
    v_perm_b32 v50, v152, v148, s47
    v_perm_b32 v51, v144, v156, s47
    v_mfma_f32_16x16x32_bf16 v[8:11], v[60:63], v[12:15], 0
    v_perm_b32 v66, v154, v150, s47
    v_perm_b32 v67, v146, v158, s47
    v_mfma_f32_16x16x32_bf16 v[4:7], v[48:51], v[16:19], v[4:7]
    s_waitcnt vmcnt(6)
    s_cmp_eq_u32 s65, 2
    s_cbranch_scc1 L_go151
    s_waitcnt vmcnt(4)
    s_cmp_eq_u32 s65, 1
    s_cbranch_scc1 L_go151
    s_waitcnt vmcnt(3)
L_go151:
    buffer_load_dwordx4 v[220:223], v91, s[36:39], s48 offen offset:3072 nt
    s_add_u32 s48, s48, 0x20000
    s_bitset0_b32 s48, 21
    s_waitcnt lgkmcnt(0)
    v_readfirstlane_b32 s66, v80
    v_readfirstlane_b32 s67, v81
    ds_read_b64 v[80:81], v94 offset:24
    s_bitcmp1_b32 s51, 19
    s_cselect_b32 s65, 2, 1
    s_cmpk_gt_i32 s66, 153
    s_cselect_b32 s65, 2, s65
    s_cmpk_gt_i32 s67, 153
    s_cselect_b32 s65, 0, s65
    v_perm_b32 v54, v157, v153, s46
    v_perm_b32 v55, v149, v145, s46
    v_mfma_f32_16x16x32_bf16 v[8:11], v[64:67], v[16:19], v[8:11]
    v_perm_b32 v70, v159, v155, s46
    v_perm_b32 v71, v151, v147, s46
    v_mfma_f32_16x16x32_bf16 v[4:7], v[52:55], v[20:23], v[4:7]
    v_perm_b32 v58, v145, v157, s47
    v_perm_b32 v59, v153, v149, s47
    v_mfma_f32_16x16x32_bf16 v[8:11], v[68:71], v[20:23], v[8:11]
    v_perm_b32 v74, v147, v159, s47
    v_perm_b32 v75, v155, v151, s47
    v_mfma_f32_16x16x32_bf16 v[4:7], v[56:59], v[24:27], v[4:7]
    s_nop 0
    v_mfma_f32_16x16x32_bf16 v[8:11], v[72:75], v[24:27], v[8:11]
    s_waitcnt vmcnt(6)
    s_cmp_eq_u32 s65, 2
    s_cbranch_scc1 L_go152
    s_waitcnt vmcnt(4)
    s_cmp_eq_u32 s65, 1
    s_cbranch_scc1 L_go152
    s_waitcnt vmcnt(3)
L_go152:
    buffer_load_dwordx4 v[224:227], v0, s[36:39], s48 offen offset:0 nt
    ds_add_u32 v94, v95 offset:20
    v_mov_b32_dpp v78, v29 row_ror:12 row_mask:0xf bank_mask:0xf
    v_perm_b32 v76, v78, v29, s46
    v_perm_b32 v77, v78, v29, s47
    s_nop 0
    v_mov_b32_dpp v12, v76 quad_perm:[0,1,2,3] row_mask:0xf bank_mask:0x1
    v_mov_b32_dpp v13, v76 row_ror:8 row_mask:0xf bank_mask:0x1
    v_mov_b32_dpp v14, v77 quad_perm:[0,1,2,3] row_mask:0xf bank_mask:0x1
    v_mov_b32_dpp v15, v77 row_ror:8 row_mask:0xf bank_mask:0x1
    v_mov_b32_dpp v16, v76 quad_perm:[0,1,2,3] row_mask:0xf bank_mask:0x2
    v_mov_b32_dpp v17, v76 row_ror:8 row_mask:0xf bank_mask:0x2
    v_mov_b32_dpp v18, v77 quad_perm:[0,1,2,3] row_mask:0xf bank_mask:0x2
    v_mov_b32_dpp v19, v77 row_ror:8 row_mask:0xf bank_mask:0x2
    s_waitcnt vmcnt(6)
    s_cmp_eq_u32 s65, 2
    s_cbranch_scc1 L_go153
    s_waitcnt vmcnt(4)
    s_cmp_eq_u32 s65, 1
    s_cbranch_scc1 L_go153
    s_waitcnt vmcnt(3)
L_go153:
    buffer_load_dwordx4 v[228:231], v0, s[36:39], s48 offen offset:1024 nt
    v_mov_b32_dpp v20, v76 quad_perm:[0,1,2,3] row_mask:0xf bank_mask:0x4
    v_mov_b32_dpp v21, v76 row_ror:8 row_mask:0xf bank_mask:0x4
    v_mov_b32_dpp v22, v77 quad_perm:[0,1,2,3] row_mask:0xf bank_mask:0x4
    v_mov_b32_dpp v23, v77 row_ror:8 row_mask:0xf bank_mask:0x4
    v_mov_b32_dpp v24, v76 quad_perm:[0,1,2,3] row_mask:0xf bank_mask:0x8
    v_mov_b32_dpp v25, v76 row_ror:8 row_mask:0xf bank_mask:0x8
    v_mov_b32_dpp v26, v77 quad_perm:[0,1,2,3] row_mask:0xf bank_mask:0x8
    v_mov_b32_dpp v27, v77 row_ror:8 row_mask:0xf bank_mask:0x8
    v_perm_b32 v44, v164, v160, s46
    v_perm_b32 v45, v172, v168, s46
    v_perm_b32 v48, v168, v164, s47
    v_perm_b32 v49, v160, v172, s47
    v_perm_b32 v52, v173, v169, s46
    v_perm_b32 v53, v165, v161, s46
    v_perm_b32 v56, v161, v173, s47
    v_perm_b32 v57, v169, v165, s47
    s_waitcnt vmcnt(6)
    s_cmp_eq_u32 s65, 2
    s_cbranch_scc1 L_go154
    s_waitcnt vmcnt(4)
    s_cmp_eq_u32 s65, 1
    s_cbranch_scc1 L_go154
    s_waitcnt vmcnt(3)
L_go154:
    buffer_load_dwordx4 v[232:235], v0, s[36:39], s48 offen offset:2048 nt
    v_perm_b32 v60, v166, v162, s46
    v_perm_b32 v61, v174, v170, s46
    v_perm_b32 v64, v170, v166, s47
    v_perm_b32 v65, v162, v174, s47
    v_perm_b32 v68, v175, v171, s46
    v_perm_b32 v69, v167, v163, s46
    v_perm_b32 v72, v163, v175, s47
    v_perm_b32 v73, v171, v167, s47
    s_waitcnt vmcnt(6)
    s_cmp_eq_u32 s65, 2
    s_cbranch_scc1 L_go155
    s_waitcnt vmcnt(4)
    s_cmp_eq_u32 s65, 1
    s_cbranch_scc1 L_go155
    s_waitcnt vmcnt(3)
L_go155:
    buffer_load_dwordx4 v[236:239], v0, s[36:39], s48 offen offset:3072 nt
    s_waitcnt lgkmcnt(0)
    v_readfirstlane_b32 s66, v80
    v_readfirstlane_b32 s67, v81
    ds_read_b64 v[80:81], v94 offset:24
    s_bitcmp1_b32 s51, 19
    s_cselect_b32 s65, 2, 1
    s_cmpk_gt_i32 s66, 157
    s_cselect_b32 s65, 2, s65
    s_cmpk_gt_i32 s67, 157
    s_cselect_b32 s65, 0, s65
    v_perm_b32 v46, v180, v176, s46
    v_perm_b32 v47, v188, v184, s46
    v_perm_b32 v62, v182, v178, s46
    v_perm_b32 v63, v190, v186, s46
    v_mfma_f32_16x16x32_bf16 v[4:7], v[44:47], v[12:15], v[4:7]
    v_perm_b32 v50, v184, v180, s47
    v_perm_b32 v51, v176, v188, s47
    v_mfma_f32_16x16x32_bf16 v[8:11], v[60:63], v[12:15], v[8:11]
    v_perm_b32 v66, v186, v182, s47
    v_perm_b32 v67, v178, v190, s47
    v_mfma_f32_16x16x32_bf16 v[4:7], v[48:51], v[16:19], v[4:7]
    s_waitcnt vmcnt(6)
    s_cmp_eq_u32 s65, 2
    s_cbranch_scc1 L_go156
    s_waitcnt vmcnt(4)
    s_cmp_eq_u32 s65, 1
    s_cbranch_scc1 L_go156
    s_waitcnt vmcnt(3)
L_go156:
    buffer_load_dwordx4 v[240:243], v91, s[36:39], s48 offen offset:0 nt
    v_perm_b32 v54, v189, v185, s46
    v_perm_b32 v55, v181, v177, s46
    v_mfma_f32_16x16x32_bf16 v[8:11], v[64:67], v[16:19], v[8:11]
    v_perm_b32 v70, v191, v187, s46
    v_perm_b32 v71, v183, v179, s46
    v_mfma_f32_16x16x32_bf16 v[4:7], v[52:55], v[20:23], v[4:7]
    v_perm_b32 v58, v177, v189, s47
    v_perm_b32 v59, v185, v181, s47
    v_mfma_f32_16x16x32_bf16 v[8:11], v[68:71], v[20:23], v[8:11]
    v_perm_b32 v74, v179, v191, s47
    v_perm_b32 v75, v187, v183, s47
    v_mfma_f32_16x16x32_bf16 v[4:7], v[56:59], v[24:27], v[4:7]
    s_nop 0
    v_mfma_f32_16x16x32_bf16 v[8:11], v[72:75], v[24:27], v[8:11]
    s_waitcnt vmcnt(6)
    s_cmp_eq_u32 s65, 2
    s_cbranch_scc1 L_go157
    s_waitcnt vmcnt(4)
    s_cmp_eq_u32 s65, 1
    s_cbranch_scc1 L_go157
    s_waitcnt vmcnt(3)
L_go157:
    buffer_load_dwordx4 v[244:247], v91, s[36:39], s48 offen offset:1024 nt
    v_mov_b32_dpp v78, v30 row_ror:12 row_mask:0xf bank_mask:0xf
    v_perm_b32 v76, v78, v30, s46
    v_perm_b32 v77, v78, v30, s47
    s_nop 0
    v_mov_b32_dpp v12, v76 quad_perm:[0,1,2,3] row_mask:0xf bank_mask:0x1
    v_mov_b32_dpp v13, v76 row_ror:8 row_mask:0xf bank_mask:0x1
    v_mov_b32_dpp v14, v77 quad_perm:[0,1,2,3] row_mask:0xf bank_mask:0x1
    v_mov_b32_dpp v15, v77 row_ror:8 row_mask:0xf bank_mask:0x1
    v_mov_b32_dpp v16, v76 quad_perm:[0,1,2,3] row_mask:0xf bank_mask:0x2
    v_mov_b32_dpp v17, v76 row_ror:8 row_mask:0xf bank_mask:0x2
    v_mov_b32_dpp v18, v77 quad_perm:[0,1,2,3] row_mask:0xf bank_mask:0x2
    v_mov_b32_dpp v19, v77 row_ror:8 row_mask:0xf bank_mask:0x2
    s_waitcnt vmcnt(6)
    s_cmp_eq_u32 s65, 2
    s_cbranch_scc1 L_go158
    s_waitcnt vmcnt(4)
    s_cmp_eq_u32 s65, 1
    s_cbranch_scc1 L_go158
    s_waitcnt vmcnt(3)
L_go158:
    buffer_load_dwordx4 v[248:251], v91, s[36:39], s48 offen offset:2048 nt
    v_mov_b32_dpp v20, v76 quad_perm:[0,1,2,3] row_mask:0xf bank_mask:0x4
    v_mov_b32_dpp v21, v76 row_ror:8 row_mask:0xf bank_mask:0x4
    v_mov_b32_dpp v22, v77 quad_perm:[0,1,2,3] row_mask:0xf bank_mask:0x4
    v_mov_b32_dpp v23, v77 row_ror:8 row_mask:0xf bank_mask:0x4
    v_mov_b32_dpp v24, v76 quad_perm:[0,1,2,3] row_mask:0xf bank_mask:0x8
    v_mov_b32_dpp v25, v76 row_ror:8 row_mask:0xf bank_mask:0x8
    v_mov_b32_dpp v26, v77 quad_perm:[0,1,2,3] row_mask:0xf bank_mask:0x8
    v_mov_b32_dpp v27, v77 row_ror:8 row_mask:0xf bank_mask:0x8
    v_perm_b32 v44, v196, v192, s46
    v_perm_b32 v45, v204, v200, s46
    v_perm_b32 v48, v200, v196, s47
    v_perm_b32 v49, v192, v204, s47
    v_perm_b32 v52, v205, v201, s46
    v_perm_b32 v53, v197, v193, s46
    v_perm_b32 v56, v193, v205, s47
    v_perm_b32 v57, v201, v197, s47
    s_waitcnt vmcnt(6)
    s_cmp_eq_u32 s65, 2
    s_cbranch_scc1 L_go159
    s_waitcnt vmcnt(4)
    s_cmp_eq_u32 s65, 1
    s_cbranch_scc1 L_go159
    s_waitcnt vmcnt(3)
L_go159:
    buffer_load_dwordx4 v[252:255], v91, s[36:39], s48 offen offset:3072 nt
    s_add_u32 s48, s48, 0x20000
    s_bitset0_b32 s48, 21
    s_waitcnt lgkmcnt(0)
    v_readfirstlane_b32 s66, v80
    v_readfirstlane_b32 s67, v81
    ds_read_b64 v[80:81], v94 offset:24
    s_bitcmp1_b32 s51, 20
    s_cselect_b32 s65, 2, 1
    s_cmpk_gt_i32 s66, 161
    s_cselect_b32 s65, 2, s65
    s_cmpk_gt_i32 s67, 161
    s_cselect_b32 s65, 0, s65
    v_perm_b32 v60, v198, v194, s46
    v_perm_b32 v61, v206, v202, s46
    v_perm_b32 v64, v202, v198, s47
    v_perm_b32 v65, v194, v206, s47
    v_perm_b32 v68, v207, v203, s46
    v_perm_b32 v69, v199, v195, s46
    v_perm_b32 v72, v195, v207, s47
    v_perm_b32 v73, v203, v199, s47
    s_waitcnt vmcnt(6)
    s_cmp_eq_u32 s65, 2
    s_cbranch_scc1 L_go160
    s_waitcnt vmcnt(4)
    s_cmp_eq_u32 s65, 1
    s_cbranch_scc1 L_go160
    s_waitcnt vmcnt(3)
L_go160:
    buffer_load_dwordx4 v[96:99], v0, s[36:39], s48 offen offset:0 nt
    v_perm_b32 v46, v212, v208, s46
    v_perm_b32 v47, v220, v216, s46
    v_perm_b32 v62, v214, v210, s46
    v_perm_b32 v63, v222, v218, s46
    v_mfma_f32_16x16x32_bf16 v[4:7], v[44:47], v[12:15], v[4:7]
    v_perm_b32 v50, v216, v212, s47
    v_perm_b32 v51, v208, v220, s47
    v_mfma_f32_16x16x32_bf16 v[8:11], v[60:63], v[12:15], v[8:11]
    v_perm_b32 v66, v218, v214, s47
    v_perm_b32 v67, v210, v222, s47
    v_mfma_f32_16x16x32_bf16 v[4:7], v[48:51], v[16:19], v[4:7]
    s_waitcnt vmcnt(6)
    s_cmp_eq_u32 s65, 2
    s_cbranch_scc1 L_go161
    s_waitcnt vmcnt(4)
    s_cmp_eq_u32 s65, 1
    s_cbranch_scc1 L_go161
    s_waitcnt vmcnt(3)
L_go161:
    buffer_load_dwordx4 v[100:103], v0, s[36:39], s48 offen offset:1024 nt
    v_perm_b32 v54, v221, v217, s46
    v_perm_b32 v55, v213, v209, s46
    v_mfma_f32_16x16x32_bf16 v[8:11], v[64:67], v[16:19], v[8:11]
    v_perm_b32 v70, v223, v219, s46
    v_perm_b32 v71, v215, v211, s46
    v_mfma_f32_16x16x32_bf16 v[4:7], v[52:55], v[20:23], v[4:7]
    v_perm_b32 v58, v209, v221, s47
    v_perm_b32 v59, v217, v213, s47
    v_mfma_f32_16x16x32_bf16 v[8:11], v[68:71], v[20:23], v[8:11]
    v_perm_b32 v74, v211, v223, s47
    v_perm_b32 v75, v219, v215, s47
    v_mfma_f32_16x16x32_bf16 v[4:7], v[56:59], v[24:27], v[4:7]
    s_nop 0
    v_mfma_f32_16x16x32_bf16 v[8:11], v[72:75], v[24:27], v[8:11]
    s_waitcnt vmcnt(6)
    s_cmp_eq_u32 s65, 2
    s_cbranch_scc1 L_go162
    s_waitcnt vmcnt(4)
    s_cmp_eq_u32 s65, 1
    s_cbranch_scc1 L_go162
    s_waitcnt vmcnt(3)
L_go162:
    buffer_load_dwordx4 v[104:107], v0, s[36:39], s48 offen offset:2048 nt
    v_mov_b32_dpp v78, v31 row_ror:12 row_mask:0xf bank_mask:0xf
    v_perm_b32 v76, v78, v31, s46
    v_perm_b32 v77, v78, v31, s47
    s_nop 0
    v_mov_b32_dpp v12, v76 quad_perm:[0,1,2,3] row_mask:0xf bank_mask:0x1
    v_mov_b32_dpp v13, v76 row_ror:8 row_mask:0xf bank_mask:0x1
    v_mov_b32_dpp v14, v77 quad_perm:[0,1,2,3] row_mask:0xf bank_mask:0x1
    v_mov_b32_dpp v15, v77 row_ror:8 row_mask:0xf bank_mask:0x1
    v_mov_b32_dpp v16, v76 quad_perm:[0,1,2,3] row_mask:0xf bank_mask:0x2
    v_mov_b32_dpp v17, v76 row_ror:8 row_mask:0xf bank_mask:0x2
    v_mov_b32_dpp v18, v77 quad_perm:[0,1,2,3] row_mask:0xf bank_mask:0x2
    v_mov_b32_dpp v19, v77 row_ror:8 row_mask:0xf bank_mask:0x2
    s_waitcnt vmcnt(6)
    s_cmp_eq_u32 s65, 2
    s_cbranch_scc1 L_go163
    s_waitcnt vmcnt(4)
    s_cmp_eq_u32 s65, 1
    s_cbranch_scc1 L_go163
    s_waitcnt vmcnt(3)
L_go163:
    buffer_load_dwordx4 v[108:111], v0, s[36:39], s48 offen offset:3072 nt
    s_waitcnt lgkmcnt(0)
    v_readfirstlane_b32 s66, v80
    v_readfirstlane_b32 s67, v81
    ds_read_b64 v[80:81], v94 offset:24
    s_bitcmp1_b32 s51, 20
    s_cselect_b32 s65, 2, 1
    s_cmpk_gt_i32 s66, 165
    s_cselect_b32 s65, 2, s65
    s_cmpk_gt_i32 s67, 165
    s_cselect_b32 s65, 0, s65
    v_mov_b32_dpp v20, v76 quad_perm:[0,1,2,3] row_mask:0xf bank_mask:0x4
    v_mov_b32_dpp v21, v76 row_ror:8 row_mask:0xf bank_mask:0x4
    v_mov_b32_dpp v22, v77 quad_perm:[0,1,2,3] row_mask:0xf bank_mask:0x4
    v_mov_b32_dpp v23, v77 row_ror:8 row_mask:0xf bank_mask:0x4
    v_mov_b32_dpp v24, v76 quad_perm:[0,1,2,3] row_mask:0xf bank_mask:0x8
    v_mov_b32_dpp v25, v76 row_ror:8 row_mask:0xf bank_mask:0x8
    v_mov_b32_dpp v26, v77 quad_perm:[0,1,2,3] row_mask:0xf bank_mask:0x8
    v_mov_b32_dpp v27, v77 row_ror:8 row_mask:0xf bank_mask:0x8
    v_perm_b32 v44, v228, v224, s46
    v_perm_b32 v45, v236, v232, s46
    v_perm_b32 v48, v232, v228, s47
    v_perm_b32 v49, v224, v236, s47
    v_perm_b32 v52, v237, v233, s46
    v_perm_b32 v53, v229, v225, s46
    v_perm_b32 v56, v225, v237, s47
    v_perm_b32 v57, v233, v229, s47
    s_waitcnt vmcnt(6)
    s_cmp_eq_u32 s65, 2
    s_cbranch_scc1 L_go164
    s_waitcnt vmcnt(4)
    s_cmp_eq_u32 s65, 1
    s_cbranch_scc1 L_go164
    s_waitcnt vmcnt(3)
L_go164:
    buffer_load_dwordx4 v[112:115], v91, s[36:39], s48 offen offset:0 nt
    v_perm_b32 v60, v230, v226, s46
    v_perm_b32 v61, v238, v234, s46
    v_perm_b32 v64, v234, v230, s47
    v_perm_b32 v65, v226, v238, s47
    v_perm_b32 v68, v239, v235, s46
    v_perm_b32 v69, v231, v227, s46
    v_perm_b32 v72, v227, v239, s47
    v_perm_b32 v73, v235, v231, s47
    s_waitcnt vmcnt(6)
    s_cmp_eq_u32 s65, 2
    s_cbranch_scc1 L_go165
    s_waitcnt vmcnt(4)
    s_cmp_eq_u32 s65, 1
    s_cbranch_scc1 L_go165
    s_waitcnt vmcnt(3)
L_go165:
    buffer_load_dwordx4 v[116:119], v91, s[36:39], s48 offen offset:1024 nt
    s_waitcnt vmcnt(6)
    s_cmp_eq_u32 s65, 2
    s_cbranch_scc1 L_go166
    s_waitcnt vmcnt(4)
    s_cmp_eq_u32 s65, 1
    s_cbranch_scc1 L_go166
    s_waitcnt vmcnt(3)
L_go166:
    buffer_load_dwordx4 v[120:123], v91, s[36:39], s48 offen offset:2048 nt
    v_perm_b32 v46, v244, v240, s46
    v_perm_b32 v47, v252, v248, s46
    v_perm_b32 v62, v246, v242, s46
    v_perm_b32 v63, v254, v250, s46
    v_mfma_f32_16x16x32_bf16 v[4:7], v[44:47], v[12:15], v[4:7]
    v_perm_b32 v50, v248, v244, s47
    v_perm_b32 v51, v240, v252, s47
    v_mfma_f32_16x16x32_bf16 v[8:11], v[60:63], v[12:15], v[8:11]
    v_perm_b32 v66, v250, v246, s47
    v_perm_b32 v67, v242, v254, s47
    v_mfma_f32_16x16x32_bf16 v[4:7], v[48:51], v[16:19], v[4:7]
    s_waitcnt vmcnt(6)
    s_cmp_eq_u32 s65, 2
    s_cbranch_scc1 L_go167
    s_waitcnt vmcnt(4)
    s_cmp_eq_u32 s65, 1
    s_cbranch_scc1 L_go167
    s_waitcnt vmcnt(3)
L_go167:
    buffer_load_dwordx4 v[124:127], v91, s[36:39], s48 offen offset:3072 nt
    s_add_u32 s48, s48, 0x20000
    s_bitset0_b32 s48, 21
    s_waitcnt lgkmcnt(0)
    v_readfirstlane_b32 s66, v80
    v_readfirstlane_b32 s67, v81
    ds_read_b64 v[80:81], v94 offset:24
    s_bitcmp1_b32 s51, 21
    s_cselect_b32 s65, 2, 1
    s_cmpk_gt_i32 s66, 169
    s_cselect_b32 s65, 2, s65
    s_cmpk_gt_i32 s67, 169
    s_cselect_b32 s65, 0, s65
    v_perm_b32 v54, v253, v249, s46
    v_perm_b32 v55, v245, v241, s46
    v_mfma_f32_16x16x32_bf16 v[8:11], v[64:67], v[16:19], v[8:11]
    v_perm_b32 v70, v255, v251, s46
    v_perm_b32 v71, v247, v243, s46
    v_mfma_f32_16x16x32_bf16 v[4:7], v[52:55], v[20:23], v[4:7]
    v_perm_b32 v58, v241, v253, s47
    v_perm_b32 v59, v249, v245, s47
    v_mfma_f32_16x16x32_bf16 v[8:11], v[68:71], v[20:23], v[8:11]
    v_perm_b32 v74, v243, v255, s47
    v_perm_b32 v75, v251, v247, s47
    v_mfma_f32_16x16x32_bf16 v[4:7], v[56:59], v[24:27], v[4:7]
    s_nop 0
    v_mfma_f32_16x16x32_bf16 v[8:11], v[72:75], v[24:27], v[8:11]
    s_waitcnt vmcnt(6)
    s_cmp_eq_u32 s65, 2
    s_cbranch_scc1 L_go168
    s_waitcnt vmcnt(4)
    s_cmp_eq_u32 s65, 1
    s_cbranch_scc1 L_go168
    s_waitcnt vmcnt(3)
L_go168:
    buffer_load_dwordx4 v[128:131], v0, s[36:39], s48 offen offset:0 nt
    v_mov_b32_dpp v78, v32 row_ror:12 row_mask:0xf bank_mask:0xf
    v_perm_b32 v76, v78, v32, s46
    v_perm_b32 v77, v78, v32, s47
    s_nop 0
    v_mov_b32_dpp v12, v76 quad_perm:[0,1,2,3] row_mask:0xf bank_mask:0x1
    v_mov_b32_dpp v13, v76 row_ror:8 row_mask:0xf bank_mask:0x1
    v_mov_b32_dpp v14, v77 quad_perm:[0,1,2,3] row_mask:0xf bank_mask:0x1
    v_mov_b32_dpp v15, v77 row_ror:8 row_mask:0xf bank_mask:0x1
    v_mov_b32_dpp v16, v76 quad_perm:[0,1,2,3] row_mask:0xf bank_mask:0x2
    v_mov_b32_dpp v17, v76 row_ror:8 row_mask:0xf bank_mask:0x2
    v_mov_b32_dpp v18, v77 quad_perm:[0,1,2,3] row_mask:0xf bank_mask:0x2
    v_mov_b32_dpp v19, v77 row_ror:8 row_mask:0xf bank_mask:0x2
    s_waitcnt vmcnt(6)
    s_cmp_eq_u32 s65, 2
    s_cbranch_scc1 L_go169
    s_waitcnt vmcnt(4)
    s_cmp_eq_u32 s65, 1
    s_cbranch_scc1 L_go169
    s_waitcnt vmcnt(3)
L_go169:
    buffer_load_dwordx4 v[132:135], v0, s[36:39], s48 offen offset:1024 nt
    v_mov_b32_dpp v20, v76 quad_perm:[0,1,2,3] row_mask:0xf bank_mask:0x4
    v_mov_b32_dpp v21, v76 row_ror:8 row_mask:0xf bank_mask:0x4
    v_mov_b32_dpp v22, v77 quad_perm:[0,1,2,3] row_mask:0xf bank_mask:0x4
    v_mov_b32_dpp v23, v77 row_ror:8 row_mask:0xf bank_mask:0x4
    v_mov_b32_dpp v24, v76 quad_perm:[0,1,2,3] row_mask:0xf bank_mask:0x8
    v_mov_b32_dpp v25, v76 row_ror:8 row_mask:0xf bank_mask:0x8
    v_mov_b32_dpp v26, v77 quad_perm:[0,1,2,3] row_mask:0xf bank_mask:0x8
    v_mov_b32_dpp v27, v77 row_ror:8 row_mask:0xf bank_mask:0x8
    s_waitcnt vmcnt(6)
    s_cmp_eq_u32 s65, 2
    s_cbranch_scc1 L_go170
    s_waitcnt vmcnt(4)
    s_cmp_eq_u32 s65, 1
    s_cbranch_scc1 L_go170
    s_waitcnt vmcnt(3)
L_go170:
    buffer_load_dwordx4 v[136:139], v0, s[36:39], s48 offen offset:2048 nt
    v_perm_b32 v44, v100, v96, s46
    v_perm_b32 v45, v108, v104, s46
    v_perm_b32 v48, v104, v100, s47
    v_perm_b32 v49, v96, v108, s47
    v_perm_b32 v52, v109, v105, s46
    v_perm_b32 v53, v101, v97, s46
    v_perm_b32 v56, v97, v109, s47
    v_perm_b32 v57, v105, v101, s47
    v_perm_b32 v60, v102, v98, s46
    v_perm_b32 v61, v110, v106, s46
    v_perm_b32 v64, v106, v102, s47
    v_perm_b32 v65, v98, v110, s47
    v_perm_b32 v68, v111, v107, s46
    v_perm_b32 v69, v103, v99, s46
    v_perm_b32 v72, v99, v111, s47
    v_perm_b32 v73, v107, v103, s47
    s_waitcnt vmcnt(6)
    s_cmp_eq_u32 s65, 2
    s_cbranch_scc1 L_go171
    s_waitcnt vmcnt(4)
    s_cmp_eq_u32 s65, 1
    s_cbranch_scc1 L_go171
    s_waitcnt vmcnt(3)
L_go171:
    buffer_load_dwordx4 v[140:143], v0, s[36:39], s48 offen offset:3072 nt
    s_waitcnt lgkmcnt(0)
    v_readfirstlane_b32 s66, v80
    v_readfirstlane_b32 s67, v81
    ds_read_b64 v[80:81], v94 offset:24
    s_bitcmp1_b32 s51, 21
    s_cselect_b32 s65, 2, 1
    s_cmpk_gt_i32 s66, 173
    s_cselect_b32 s65, 2, s65
    s_cmpk_gt_i32 s67, 173
    s_cselect_b32 s65, 0, s65
    s_waitcnt vmcnt(6)
    s_cmp_eq_u32 s65, 2
    s_cbranch_scc1 L_go172
    s_waitcnt vmcnt(4)
    s_cmp_eq_u32 s65, 1
    s_cbranch_scc1 L_go172
    s_waitcnt vmcnt(3)
L_go172:
    buffer_load_dwordx4 v[144:147], v91, s[36:39], s48 offen offset:0 nt
    s_waitcnt vmcnt(6)
    s_cmp_eq_u32 s65, 2
    s_cbranch_scc1 L_go173
    s_waitcnt vmcnt(4)
    s_cmp_eq_u32 s65, 1
    s_cbranch_scc1 L_go173
    s_waitcnt vmcnt(3)
L_go173:
    buffer_load_dwordx4 v[148:151], v91, s[36:39], s48 offen offset:1024 nt
    s_waitcnt vmcnt(6)
    s_cmp_eq_u32 s65, 2
    s_cbranch_scc1 L_go174
    s_waitcnt vmcnt(4)
    s_cmp_eq_u32 s65, 1
    s_cbranch_scc1 L_go174
    s_waitcnt vmcnt(3)
L_go174:
    buffer_load_dwordx4 v[152:155], v91, s[36:39], s48 offen offset:2048 nt
    v_perm_b32 v46, v116, v112, s46
    v_perm_b32 v47, v124, v120, s46
    v_perm_b32 v62, v118, v114, s46
    v_perm_b32 v63, v126, v122, s46
    v_mfma_f32_16x16x32_bf16 v[4:7], v[44:47], v[12:15], v[4:7]
    v_perm_b32 v50, v120, v116, s47
    v_perm_b32 v51, v112, v124, s47
    v_mfma_f32_16x16x32_bf16 v[8:11], v[60:63], v[12:15], v[8:11]
    v_perm_b32 v66, v122, v118, s47
    v_perm_b32 v67, v114, v126, s47
    v_mfma_f32_16x16x32_bf16 v[4:7], v[48:51], v[16:19], v[4:7]
    s_waitcnt vmcnt(6)
    s_cmp_eq_u32 s65, 2
    s_cbranch_scc1 L_go175
    s_waitcnt vmcnt(4)
    s_cmp_eq_u32 s65, 1
    s_cbranch_scc1 L_go175
    s_waitcnt vmcnt(3)
L_go175:
    buffer_load_dwordx4 v[156:159], v91, s[36:39], s48 offen offset:3072 nt
    s_add_u32 s48, s48, 0x20000
    s_bitset0_b32 s48, 21
    s_waitcnt lgkmcnt(0)
    v_readfirstlane_b32 s66, v80
    v_readfirstlane_b32 s67, v81
    ds_read_b64 v[80:81], v94 offset:24
    s_bitcmp1_b32 s51, 22
    s_cselect_b32 s65, 2, 1
    s_cmpk_gt_i32 s66, 177
    s_cselect_b32 s65, 2, s65
    s_cmpk_gt_i32 s67, 177
    s_cselect_b32 s65, 0, s65
    v_perm_b32 v54, v125, v121, s46
    v_perm_b32 v55, v117, v113, s46
    v_mfma_f32_16x16x32_bf16 v[8:11], v[64:67], v[16:19], v[8:11]
    v_perm_b32 v70, v127, v123, s46
    v_perm_b32 v71, v119, v115, s46
    v_mfma_f32_16x16x32_bf16 v[4:7], v[52:55], v[20:23], v[4:7]
    v_perm_b32 v58, v113, v125, s47
    v_perm_b32 v59, v121, v117, s47
    v_mfma_f32_16x16x32_bf16 v[8:11], v[68:71], v[20:23], v[8:11]
    v_perm_b32 v74, v115, v127, s47
    v_perm_b32 v75, v123, v119, s47
    v_mfma_f32_16x16x32_bf16 v[4:7], v[56:59], v[24:27], v[4:7]
    s_nop 0
    v_mfma_f32_16x16x32_bf16 v[8:11], v[72:75], v[24:27], v[8:11]
    s_waitcnt vmcnt(6)
    s_cmp_eq_u32 s65, 2
    s_cbranch_scc1 L_go176
    s_waitcnt vmcnt(4)
    s_cmp_eq_u32 s65, 1
    s_cbranch_scc1 L_go176
    s_waitcnt vmcnt(3)
L_go176:
    buffer_load_dwordx4 v[160:163], v0, s[36:39], s48 offen offset:0 nt
    v_mov_b32_dpp v78, v33 row_ror:12 row_mask:0xf bank_mask:0xf
    v_perm_b32 v76, v78, v33, s46
    v_perm_b32 v77, v78, v33, s47
    s_nop 0
    v_mov_b32_dpp v12, v76 quad_perm:[0,1,2,3] row_mask:0xf bank_mask:0x1
    v_mov_b32_dpp v13, v76 row_ror:8 row_mask:0xf bank_mask:0x1
    v_mov_b32_dpp v14, v77 quad_perm:[0,1,2,3] row_mask:0xf bank_mask:0x1
    v_mov_b32_dpp v15, v77 row_ror:8 row_mask:0xf bank_mask:0x1
    v_mov_b32_dpp v16, v76 quad_perm:[0,1,2,3] row_mask:0xf bank_mask:0x2
    v_mov_b32_dpp v17, v76 row_ror:8 row_mask:0xf bank_mask:0x2
    v_mov_b32_dpp v18, v77 quad_perm:[0,1,2,3] row_mask:0xf bank_mask:0x2
    v_mov_b32_dpp v19, v77 row_ror:8 row_mask:0xf bank_mask:0x2
    s_waitcnt vmcnt(6)
    s_cmp_eq_u32 s65, 2
    s_cbranch_scc1 L_go177
    s_waitcnt vmcnt(4)
    s_cmp_eq_u32 s65, 1
    s_cbranch_scc1 L_go177
    s_waitcnt vmcnt(3)
L_go177:
    buffer_load_dwordx4 v[164:167], v0, s[36:39], s48 offen offset:1024 nt
    v_mov_b32_dpp v20, v76 quad_perm:[0,1,2,3] row_mask:0xf bank_mask:0x4
    v_mov_b32_dpp v21, v76 row_ror:8 row_mask:0xf bank_mask:0x4
    v_mov_b32_dpp v22, v77 quad_perm:[0,1,2,3] row_mask:0xf bank_mask:0x4
    v_mov_b32_dpp v23, v77 row_ror:8 row_mask:0xf bank_mask:0x4
    v_mov_b32_dpp v24, v76 quad_perm:[0,1,2,3] row_mask:0xf bank_mask:0x8
    v_mov_b32_dpp v25, v76 row_ror:8 row_mask:0xf bank_mask:0x8
    v_mov_b32_dpp v26, v77 quad_perm:[0,1,2,3] row_mask:0xf bank_mask:0x8
    v_mov_b32_dpp v27, v77 row_ror:8 row_mask:0xf bank_mask:0x8
    s_waitcnt vmcnt(6)
    s_cmp_eq_u32 s65, 2
    s_cbranch_scc1 L_go178
    s_waitcnt vmcnt(4)
    s_cmp_eq_u32 s65, 1
    s_cbranch_scc1 L_go178
    s_waitcnt vmcnt(3)
L_go178:
    buffer_load_dwordx4 v[168:171], v0, s[36:39], s48 offen offset:2048 nt
    v_perm_b32 v44, v132, v128, s46
    v_perm_b32 v45, v140, v136, s46
    v_perm_b32 v48, v136, v132, s47
    v_perm_b32 v49, v128, v140, s47
    v_perm_b32 v52, v141, v137, s46
    v_perm_b32 v53, v133, v129, s46
    v_perm_b32 v56, v129, v141, s47
    v_perm_b32 v57, v137, v133, s47
    v_perm_b32 v60, v134, v130, s46
    v_perm_b32 v61, v142, v138, s46
    v_perm_b32 v64, v138, v134, s47
    v_perm_b32 v65, v130, v142, s47
    v_perm_b32 v68, v143, v139, s46
    v_perm_b32 v69, v135, v131, s46
    v_perm_b32 v72, v131, v143, s47
    v_perm_b32 v73, v139, v135, s47
    s_waitcnt vmcnt(6)
    s_cmp_eq_u32 s65, 2
    s_cbranch_scc1 L_go179
    s_waitcnt vmcnt(4)
    s_cmp_eq_u32 s65, 1
    s_cbranch_scc1 L_go179
    s_waitcnt vmcnt(3)
L_go179:
    buffer_load_dwordx4 v[172:175], v0, s[36:39], s48 offen offset:3072 nt
    s_waitcnt lgkmcnt(0)
    v_readfirstlane_b32 s66, v80
    v_readfirstlane_b32 s67, v81
    ds_read_b64 v[80:81], v94 offset:24
    s_bitcmp1_b32 s51, 22
    s_cselect_b32 s65, 2, 1
    s_cmpk_gt_i32 s66, 181
    s_cselect_b32 s65, 2, s65
    s_cmpk_gt_i32 s67, 181
    s_cselect_b32 s65, 0, s65
    s_waitcnt vmcnt(6)
    s_cmp_eq_u32 s65, 2
    s_cbranch_scc1 L_go180
    s_waitcnt vmcnt(4)
    s_cmp_eq_u32 s65, 1
    s_cbranch_scc1 L_go180
    s_waitcnt vmcnt(3)
L_go180:
    buffer_load_dwordx4 v[176:179], v91, s[36:39], s48 offen offset:0 nt
    ds_add_u32 v94, v95 offset:20
    s_waitcnt vmcnt(6)
    s_cmp_eq_u32 s65, 2
    s_cbranch_scc1 L_go181
    s_waitcnt vmcnt(4)
    s_cmp_eq_u32 s65, 1
    s_cbranch_scc1 L_go181
    s_waitcnt vmcnt(3)
L_go181:
    buffer_load_dwordx4 v[180:183], v91, s[36:39], s48 offen offset:1024 nt
    s_waitcnt vmcnt(6)
    s_cmp_eq_u32 s65, 2
    s_cbranch_scc1 L_go182
    s_waitcnt vmcnt(4)
    s_cmp_eq_u32 s65, 1
    s_cbranch_scc1 L_go182
    s_waitcnt vmcnt(3)
L_go182:
    buffer_load_dwordx4 v[184:187], v91, s[36:39], s48 offen offset:2048 nt
    v_perm_b32 v46, v148, v144, s46
    v_perm_b32 v47, v156, v152, s46
    v_perm_b32 v62, v150, v146, s46
    v_perm_b32 v63, v158, v154, s46
    v_mfma_f32_16x16x32_bf16 v[4:7], v[44:47], v[12:15], v[4:7]
    v_perm_b32 v50, v152, v148, s47
    v_perm_b32 v51, v144, v156, s47
    v_mfma_f32_16x16x32_bf16 v[8:11], v[60:63], v[12:15], v[8:11]
    v_perm_b32 v66, v154, v150, s47
    v_perm_b32 v67, v146, v158, s47
    v_mfma_f32_16x16x32_bf16 v[4:7], v[48:51], v[16:19], v[4:7]
    s_waitcnt vmcnt(6)
    s_cmp_eq_u32 s65, 2
    s_cbranch_scc1 L_go183
    s_waitcnt vmcnt(4)
    s_cmp_eq_u32 s65, 1
    s_cbranch_scc1 L_go183
    s_waitcnt vmcnt(3)
L_go183:
    buffer_load_dwordx4 v[188:191], v91, s[36:39], s48 offen offset:3072 nt
    s_add_u32 s48, s48, 0x20000
    s_bitset0_b32 s48, 21
    s_waitcnt lgkmcnt(0)
    v_readfirstlane_b32 s66, v80
    v_readfirstlane_b32 s67, v81
    ds_read_b64 v[80:81], v94 offset:24
    s_bitcmp1_b32 s51, 23
    s_cselect_b32 s65, 2, 1
    s_cmpk_gt_i32 s66, 185
    s_cselect_b32 s65, 2, s65
    s_cmpk_gt_i32 s67, 185
    s_cselect_b32 s65, 0, s65
    v_perm_b32 v54, v157, v153, s46
    v_perm_b32 v55, v149, v145, s46
    v_mfma_f32_16x16x32_bf16 v[8:11], v[64:67], v[16:19], v[8:11]
    v_perm_b32 v70, v159, v155, s46
    v_perm_b32 v71, v151, v147, s46
    v_mfma_f32_16x16x32_bf16 v[4:7], v[52:55], v[20:23], v[4:7]
    v_perm_b32 v58, v145, v157, s47
    v_perm_b32 v59, v153, v149, s47
    v_mfma_f32_16x16x32_bf16 v[8:11], v[68:71], v[20:23], v[8:11]
    v_perm_b32 v74, v147, v159, s47
    v_perm_b32 v75, v155, v151, s47
    v_mfma_f32_16x16x32_bf16 v[4:7], v[56:59], v[24:27], v[4:7]
    s_nop 0
    v_mfma_f32_16x16x32_bf16 v[8:11], v[72:75], v[24:27], v[8:11]
    s_waitcnt vmcnt(6)
    s_cmp_eq_u32 s65, 2
    s_cbranch_scc1 L_go184
    s_waitcnt vmcnt(4)
    s_cmp_eq_u32 s65, 1
    s_cbranch_scc1 L_go184
    s_waitcnt vmcnt(3)
L_go184:
    buffer_load_dwordx4 v[192:195], v0, s[36:39], s48 offen offset:0 nt
    v_mov_b32_dpp v78, v34 row_ror:12 row_mask:0xf bank_mask:0xf
    v_perm_b32 v76, v78, v34, s46
    v_perm_b32 v77, v78, v34, s47
    s_nop 0
    v_mov_b32_dpp v12, v76 quad_perm:[0,1,2,3] row_mask:0xf bank_mask:0x1
    v_mov_b32_dpp v13, v76 row_ror:8 row_mask:0xf bank_mask:0x1
    v_mov_b32_dpp v14, v77 quad_perm:[0,1,2,3] row_mask:0xf bank_mask:0x1
    v_mov_b32_dpp v15, v77 row_ror:8 row_mask:0xf bank_mask:0x1
    v_mov_b32_dpp v16, v76 quad_perm:[0,1,2,3] row_mask:0xf bank_mask:0x2
    v_mov_b32_dpp v17, v76 row_ror:8 row_mask:0xf bank_mask:0x2
    v_mov_b32_dpp v18, v77 quad_perm:[0,1,2,3] row_mask:0xf bank_mask:0x2
    v_mov_b32_dpp v19, v77 row_ror:8 row_mask:0xf bank_mask:0x2
    s_waitcnt vmcnt(6)
    s_cmp_eq_u32 s65, 2
    s_cbranch_scc1 L_go185
    s_waitcnt vmcnt(4)
    s_cmp_eq_u32 s65, 1
    s_cbranch_scc1 L_go185
    s_waitcnt vmcnt(3)
L_go185:
    buffer_load_dwordx4 v[196:199], v0, s[36:39], s48 offen offset:1024 nt
    v_mov_b32_dpp v20, v76 quad_perm:[0,1,2,3] row_mask:0xf bank_mask:0x4
    v_mov_b32_dpp v21, v76 row_ror:8 row_mask:0xf bank_mask:0x4
    v_mov_b32_dpp v22, v77 quad_perm:[0,1,2,3] row_mask:0xf bank_mask:0x4
    v_mov_b32_dpp v23, v77 row_ror:8 row_mask:0xf bank_mask:0x4
    v_mov_b32_dpp v24, v76 quad_perm:[0,1,2,3] row_mask:0xf bank_mask:0x8
    v_mov_b32_dpp v25, v76 row_ror:8 row_mask:0xf bank_mask:0x8
    v_mov_b32_dpp v26, v77 quad_perm:[0,1,2,3] row_mask:0xf bank_mask:0x8
    v_mov_b32_dpp v27, v77 row_ror:8 row_mask:0xf bank_mask:0x8
    s_waitcnt vmcnt(6)
    s_cmp_eq_u32 s65, 2
    s_cbranch_scc1 L_go186
    s_waitcnt vmcnt(4)
    s_cmp_eq_u32 s65, 1
    s_cbranch_scc1 L_go186
    s_waitcnt vmcnt(3)
L_go186:
    buffer_load_dwordx4 v[200:203], v0, s[36:39], s48 offen offset:2048 nt
    v_perm_b32 v44, v164, v160, s46
    v_perm_b32 v45, v172, v168, s46
    v_perm_b32 v48, v168, v164, s47
    v_perm_b32 v49, v160, v172, s47
    v_perm_b32 v52, v173, v169, s46
    v_perm_b32 v53, v165, v161, s46
    v_perm_b32 v56, v161, v173, s47
    v_perm_b32 v57, v169, v165, s47
    v_perm_b32 v60, v166, v162, s46
    v_perm_b32 v61, v174, v170, s46
    v_perm_b32 v64, v170, v166, s47
    v_perm_b32 v65, v162, v174, s47
    v_perm_b32 v68, v175, v171, s46
    v_perm_b32 v69, v167, v163, s46
    v_perm_b32 v72, v163, v175, s47
    v_perm_b32 v73, v171, v167, s47
    s_waitcnt vmcnt(6)
    s_cmp_eq_u32 s65, 2
    s_cbranch_scc1 L_go187
    s_waitcnt vmcnt(4)
    s_cmp_eq_u32 s65, 1
    s_cbranch_scc1 L_go187
    s_waitcnt vmcnt(3)
L_go187:
    buffer_load_dwordx4 v[204:207], v0, s[36:39], s48 offen offset:3072 nt
    s_waitcnt lgkmcnt(0)
    v_readfirstlane_b32 s66, v80
    v_readfirstlane_b32 s67, v81
    ds_read_b64 v[80:81], v94 offset:24
    s_bitcmp1_b32 s51, 23
    s_cselect_b32 s65, 2, 1
    s_cmpk_gt_i32 s66, 189
    s_cselect_b32 s65, 2, s65
    s_cmpk_gt_i32 s67, 189
    s_cselect_b32 s65, 0, s65
    s_waitcnt vmcnt(6)
    s_cmp_eq_u32 s65, 2
    s_cbranch_scc1 L_go188
    s_waitcnt vmcnt(4)
    s_cmp_eq_u32 s65, 1
    s_cbranch_scc1 L_go188
    s_waitcnt vmcnt(3)
L_go188:
    buffer_load_dwordx4 v[208:211], v91, s[36:39], s48 offen offset:0 nt
    s_waitcnt vmcnt(6)
    s_cmp_eq_u32 s65, 2
    s_cbranch_scc1 L_go189
    s_waitcnt vmcnt(4)
    s_cmp_eq_u32 s65, 1
    s_cbranch_scc1 L_go189
    s_waitcnt vmcnt(3)
L_go189:
    buffer_load_dwordx4 v[212:215], v91, s[36:39], s48 offen offset:1024 nt
    s_waitcnt vmcnt(6)
    s_cmp_eq_u32 s65, 2
    s_cbranch_scc1 L_go190
    s_waitcnt vmcnt(4)
    s_cmp_eq_u32 s65, 1
    s_cbranch_scc1 L_go190
    s_waitcnt vmcnt(3)
L_go190:
    buffer_load_dwordx4 v[216:219], v91, s[36:39], s48 offen offset:2048 nt
    v_perm_b32 v46, v180, v176, s46
    v_perm_b32 v47, v188, v184, s46
    v_perm_b32 v62, v182, v178, s46
    v_perm_b32 v63, v190, v186, s46
    v_mfma_f32_16x16x32_bf16 v[4:7], v[44:47], v[12:15], v[4:7]
    v_perm_b32 v50, v184, v180, s47
    v_perm_b32 v51, v176, v188, s47
    v_mfma_f32_16x16x32_bf16 v[8:11], v[60:63], v[12:15], v[8:11]
    v_perm_b32 v66, v186, v182, s47
    v_perm_b32 v67, v178, v190, s47
    v_mfma_f32_16x16x32_bf16 v[4:7], v[48:51], v[16:19], v[4:7]
    s_waitcnt vmcnt(6)
    s_cmp_eq_u32 s65, 2
    s_cbranch_scc1 L_go191
    s_waitcnt vmcnt(4)
    s_cmp_eq_u32 s65, 1
    s_cbranch_scc1 L_go191
    s_waitcnt vmcnt(3)
L_go191:
    buffer_load_dwordx4 v[220:223], v91, s[36:39], s48 offen offset:3072 nt
    s_add_u32 s48, s48, 0x20000
    s_bitset0_b32 s48, 21
    s_waitcnt lgkmcnt(0)
    v_readfirstlane_b32 s66, v80
    v_readfirstlane_b32 s67, v81
    ds_read_b64 v[80:81], v94 offset:24
    s_bitcmp1_b32 s51, 24
    s_cselect_b32 s65, 2, 1
    s_cmpk_gt_i32 s66, 193
    s_cselect_b32 s65, 2, s65
    s_cmpk_gt_i32 s67, 193
    s_cselect_b32 s65, 0, s65
    v_perm_b32 v54, v189, v185, s46
    v_perm_b32 v55, v181, v177, s46
    v_mfma_f32_16x16x32_bf16 v[8:11], v[64:67], v[16:19], v[8:11]
    v_perm_b32 v70, v191, v187, s46
    v_perm_b32 v71, v183, v179, s46
    v_mfma_f32_16x16x32_bf16 v[4:7], v[52:55], v[20:23], v[4:7]
    v_perm_b32 v58, v177, v189, s47
    v_perm_b32 v59, v185, v181, s47
    v_mfma_f32_16x16x32_bf16 v[8:11], v[68:71], v[20:23], v[8:11]
    v_perm_b32 v74, v179, v191, s47
    v_perm_b32 v75, v187, v183, s47
    v_mfma_f32_16x16x32_bf16 v[4:7], v[56:59], v[24:27], v[4:7]
    s_nop 0
    v_mfma_f32_16x16x32_bf16 v[8:11], v[72:75], v[24:27], v[8:11]
    s_waitcnt vmcnt(6)
    s_cmp_eq_u32 s65, 2
    s_cbranch_scc1 L_go192
    s_waitcnt vmcnt(4)
    s_cmp_eq_u32 s65, 1
    s_cbranch_scc1 L_go192
    s_waitcnt vmcnt(3)
L_go192:
    buffer_load_dwordx4 v[224:227], v0, s[36:39], s48 offen offset:0 nt
    v_mov_b32_dpp v78, v35 row_ror:12 row_mask:0xf bank_mask:0xf
    v_perm_b32 v76, v78, v35, s46
    v_perm_b32 v77, v78, v35, s47
    s_nop 0
    v_mov_b32_dpp v12, v76 quad_perm:[0,1,2,3] row_mask:0xf bank_mask:0x1
    v_mov_b32_dpp v13, v76 row_ror:8 row_mask:0xf bank_mask:0x1
    v_mov_b32_dpp v14, v77 quad_perm:[0,1,2,3] row_mask:0xf bank_mask:0x1
    v_mov_b32_dpp v15, v77 row_ror:8 row_mask:0xf bank_mask:0x1
    v_mov_b32_dpp v16, v76 quad_perm:[0,1,2,3] row_mask:0xf bank_mask:0x2
    v_mov_b32_dpp v17, v76 row_ror:8 row_mask:0xf bank_mask:0x2
    v_mov_b32_dpp v18, v77 quad_perm:[0,1,2,3] row_mask:0xf bank_mask:0x2
    v_mov_b32_dpp v19, v77 row_ror:8 row_mask:0xf bank_mask:0x2
    s_waitcnt vmcnt(6)
    s_cmp_eq_u32 s65, 2
    s_cbranch_scc1 L_go193
    s_waitcnt vmcnt(4)
    s_cmp_eq_u32 s65, 1
    s_cbranch_scc1 L_go193
    s_waitcnt vmcnt(3)
L_go193:
    buffer_load_dwordx4 v[228:231], v0, s[36:39], s48 offen offset:1024 nt
    v_mov_b32_dpp v20, v76 quad_perm:[0,1,2,3] row_mask:0xf bank_mask:0x4
    v_mov_b32_dpp v21, v76 row_ror:8 row_mask:0xf bank_mask:0x4
    v_mov_b32_dpp v22, v77 quad_perm:[0,1,2,3] row_mask:0xf bank_mask:0x4
    v_mov_b32_dpp v23, v77 row_ror:8 row_mask:0xf bank_mask:0x4
    v_mov_b32_dpp v24, v76 quad_perm:[0,1,2,3] row_mask:0xf bank_mask:0x8
    v_mov_b32_dpp v25, v76 row_ror:8 row_mask:0xf bank_mask:0x8
    v_mov_b32_dpp v26, v77 quad_perm:[0,1,2,3] row_mask:0xf bank_mask:0x8
    v_mov_b32_dpp v27, v77 row_ror:8 row_mask:0xf bank_mask:0x8
    s_waitcnt vmcnt(6)
    s_cmp_eq_u32 s65, 2
    s_cbranch_scc1 L_go194
    s_waitcnt vmcnt(4)
    s_cmp_eq_u32 s65, 1
    s_cbranch_scc1 L_go194
    s_waitcnt vmcnt(3)
L_go194:
    buffer_load_dwordx4 v[232:235], v0, s[36:39], s48 offen offset:2048 nt
    v_perm_b32 v44, v196, v192, s46
    v_perm_b32 v45, v204, v200, s46
    v_perm_b32 v48, v200, v196, s47
    v_perm_b32 v49, v192, v204, s47
    v_perm_b32 v52, v205, v201, s46
    v_perm_b32 v53, v197, v193, s46
    v_perm_b32 v56, v193, v205, s47
    v_perm_b32 v57, v201, v197, s47
    v_perm_b32 v60, v198, v194, s46
    v_perm_b32 v61, v206, v202, s46
    v_perm_b32 v64, v202, v198, s47
    v_perm_b32 v65, v194, v206, s47
    v_perm_b32 v68, v207, v203, s46
    v_perm_b32 v69, v199, v195, s46
    v_perm_b32 v72, v195, v207, s47
    v_perm_b32 v73, v203, v199, s47
    s_waitcnt vmcnt(6)
    s_cmp_eq_u32 s65, 2
    s_cbranch_scc1 L_go195
    s_waitcnt vmcnt(4)
    s_cmp_eq_u32 s65, 1
    s_cbranch_scc1 L_go195
    s_waitcnt vmcnt(3)
L_go195:
    buffer_load_dwordx4 v[236:239], v0, s[36:39], s48 offen offset:3072 nt
    s_waitcnt lgkmcnt(0)
    v_readfirstlane_b32 s66, v80
    v_readfirstlane_b32 s67, v81
    ds_read_b64 v[80:81], v94 offset:24
    s_bitcmp1_b32 s51, 24
    s_cselect_b32 s65, 2, 1
    s_cmpk_gt_i32 s66, 197
    s_cselect_b32 s65, 2, s65
    s_cmpk_gt_i32 s67, 197
    s_cselect_b32 s65, 0, s65
    s_waitcnt vmcnt(6)
    s_cmp_eq_u32 s65, 2
    s_cbranch_scc1 L_go196
    s_waitcnt vmcnt(4)
    s_cmp_eq_u32 s65, 1
    s_cbranch_scc1 L_go196
    s_waitcnt vmcnt(3)
L_go196:
    buffer_load_dwordx4 v[240:243], v91, s[36:39], s48 offen offset:0 nt
    s_waitcnt vmcnt(6)
    s_cmp_eq_u32 s65, 2
    s_cbranch_scc1 L_go197
    s_waitcnt vmcnt(4)
    s_cmp_eq_u32 s65, 1
    s_cbranch_scc1 L_go197
    s_waitcnt vmcnt(3)
L_go197:
    buffer_load_dwordx4 v[244:247], v91, s[36:39], s48 offen offset:1024 nt
    s_waitcnt vmcnt(6)
    s_cmp_eq_u32 s65, 2
    s_cbranch_scc1 L_go198
    s_waitcnt vmcnt(4)
    s_cmp_eq_u32 s65, 1
    s_cbranch_scc1 L_go198
    s_waitcnt vmcnt(3)
L_go198:
    buffer_load_dwordx4 v[248:251], v91, s[36:39], s48 offen offset:2048 nt
    v_perm_b32 v46, v212, v208, s46
    v_perm_b32 v47, v220, v216, s46
    v_perm_b32 v62, v214, v210, s46
    v_perm_b32 v63, v222, v218, s46
    v_mfma_f32_16x16x32_bf16 v[4:7], v[44:47], v[12:15], v[4:7]
    v_perm_b32 v50, v216, v212, s47
    v_perm_b32 v51, v208, v220, s47
    v_mfma_f32_16x16x32_bf16 v[8:11], v[60:63], v[12:15], v[8:11]
    v_perm_b32 v66, v218, v214, s47
    v_perm_b32 v67, v210, v222, s47
    v_mfma_f32_16x16x32_bf16 v[4:7], v[48:51], v[16:19], v[4:7]
    s_waitcnt vmcnt(6)
    s_cmp_eq_u32 s65, 2
    s_cbranch_scc1 L_go199
    s_waitcnt vmcnt(4)
    s_cmp_eq_u32 s65, 1
    s_cbranch_scc1 L_go199
    s_waitcnt vmcnt(3)
L_go199:
    buffer_load_dwordx4 v[252:255], v91, s[36:39], s48 offen offset:3072 nt
    s_add_u32 s48, s48, 0x20000
    s_bitset0_b32 s48, 21
    s_waitcnt lgkmcnt(0)
    v_readfirstlane_b32 s66, v80
    v_readfirstlane_b32 s67, v81
    ds_read_b64 v[80:81], v94 offset:24
    s_bitcmp1_b32 s51, 25
    s_cselect_b32 s65, 2, 1
    s_cmpk_gt_i32 s66, 201
    s_cselect_b32 s65, 2, s65
    s_cmpk_gt_i32 s67, 201
    s_cselect_b32 s65, 0, s65
    v_perm_b32 v54, v221, v217, s46
    v_perm_b32 v55, v213, v209, s46
    v_mfma_f32_16x16x32_bf16 v[8:11], v[64:67], v[16:19], v[8:11]
    v_perm_b32 v70, v223, v219, s46
    v_perm_b32 v71, v215, v211, s46
    v_mfma_f32_16x16x32_bf16 v[4:7], v[52:55], v[20:23], v[4:7]
    v_perm_b32 v58, v209, v221, s47
    v_perm_b32 v59, v217, v213, s47
    v_mfma_f32_16x16x32_bf16 v[8:11], v[68:71], v[20:23], v[8:11]
    v_perm_b32 v74, v211, v223, s47
    v_perm_b32 v75, v219, v215, s47
    v_mfma_f32_16x16x32_bf16 v[4:7], v[56:59], v[24:27], v[4:7]
    s_nop 0
    v_mfma_f32_16x16x32_bf16 v[8:11], v[72:75], v[24:27], v[8:11]
    s_waitcnt vmcnt(6)
    s_cmp_eq_u32 s65, 2
    s_cbranch_scc1 L_go200
    s_waitcnt vmcnt(4)
    s_cmp_eq_u32 s65, 1
    s_cbranch_scc1 L_go200
    s_waitcnt vmcnt(3)
L_go200:
    buffer_load_dwordx4 v[96:99], v0, s[36:39], s48 offen offset:0 nt
    v_mov_b32_dpp v78, v36 row_ror:12 row_mask:0xf bank_mask:0xf
    v_perm_b32 v76, v78, v36, s46
    v_perm_b32 v77, v78, v36, s47
    s_nop 0
    v_mov_b32_dpp v12, v76 quad_perm:[0,1,2,3] row_mask:0xf bank_mask:0x1
    v_mov_b32_dpp v13, v76 row_ror:8 row_mask:0xf bank_mask:0x1
    v_mov_b32_dpp v14, v77 quad_perm:[0,1,2,3] row_mask:0xf bank_mask:0x1
    v_mov_b32_dpp v15, v77 row_ror:8 row_mask:0xf bank_mask:0x1
    v_mov_b32_dpp v16, v76 quad_perm:[0,1,2,3] row_mask:0xf bank_mask:0x2
    v_mov_b32_dpp v17, v76 row_ror:8 row_mask:0xf bank_mask:0x2
    v_mov_b32_dpp v18, v77 quad_perm:[0,1,2,3] row_mask:0xf bank_mask:0x2
    v_mov_b32_dpp v19, v77 row_ror:8 row_mask:0xf bank_mask:0x2
    s_waitcnt vmcnt(6)
    s_cmp_eq_u32 s65, 2
    s_cbranch_scc1 L_go201
    s_waitcnt vmcnt(4)
    s_cmp_eq_u32 s65, 1
    s_cbranch_scc1 L_go201
    s_waitcnt vmcnt(3)
L_go201:
    buffer_load_dwordx4 v[100:103], v0, s[36:39], s48 offen offset:1024 nt
    v_mov_b32_dpp v20, v76 quad_perm:[0,1,2,3] row_mask:0xf bank_mask:0x4
    v_mov_b32_dpp v21, v76 row_ror:8 row_mask:0xf bank_mask:0x4
    v_mov_b32_dpp v22, v77 quad_perm:[0,1,2,3] row_mask:0xf bank_mask:0x4
    v_mov_b32_dpp v23, v77 row_ror:8 row_mask:0xf bank_mask:0x4
    v_mov_b32_dpp v24, v76 quad_perm:[0,1,2,3] row_mask:0xf bank_mask:0x8
    v_mov_b32_dpp v25, v76 row_ror:8 row_mask:0xf bank_mask:0x8
    v_mov_b32_dpp v26, v77 quad_perm:[0,1,2,3] row_mask:0xf bank_mask:0x8
    v_mov_b32_dpp v27, v77 row_ror:8 row_mask:0xf bank_mask:0x8
    s_waitcnt vmcnt(6)
    s_cmp_eq_u32 s65, 2
    s_cbranch_scc1 L_go202
    s_waitcnt vmcnt(4)
    s_cmp_eq_u32 s65, 1
    s_cbranch_scc1 L_go202
    s_waitcnt vmcnt(3)
L_go202:
    buffer_load_dwordx4 v[104:107], v0, s[36:39], s48 offen offset:2048 nt
    v_perm_b32 v44, v228, v224, s46
    v_perm_b32 v45, v236, v232, s46
    v_perm_b32 v48, v232, v228, s47
    v_perm_b32 v49, v224, v236, s47
    v_perm_b32 v52, v237, v233, s46
    v_perm_b32 v53, v229, v225, s46
    v_perm_b32 v56, v225, v237, s47
    v_perm_b32 v57, v233, v229, s47
    v_perm_b32 v60, v230, v226, s46
    v_perm_b32 v61, v238, v234, s46
    v_perm_b32 v64, v234, v230, s47
    v_perm_b32 v65, v226, v238, s47
    v_perm_b32 v68, v239, v235, s46
    v_perm_b32 v69, v231, v227, s46
    v_perm_b32 v72, v227, v239, s47
    v_perm_b32 v73, v235, v231, s47
    s_waitcnt vmcnt(6)
    s_cmp_eq_u32 s65, 2
    s_cbranch_scc1 L_go203
    s_waitcnt vmcnt(4)
    s_cmp_eq_u32 s65, 1
    s_cbranch_scc1 L_go203
    s_waitcnt vmcnt(3)
L_go203:
    buffer_load_dwordx4 v[108:111], v0, s[36:39], s48 offen offset:3072 nt
    s_waitcnt lgkmcnt(0)
    v_readfirstlane_b32 s66, v80
    v_readfirstlane_b32 s67, v81
    ds_read_b64 v[80:81], v94 offset:24
    s_bitcmp1_b32 s51, 25
    s_cselect_b32 s65, 2, 1
    s_cmpk_gt_i32 s66, 205
    s_cselect_b32 s65, 2, s65
    s_cmpk_gt_i32 s67, 205
    s_cselect_b32 s65, 0, s65
    s_waitcnt vmcnt(6)
    s_cmp_eq_u32 s65, 2
    s_cbranch_scc1 L_go204
    s_waitcnt vmcnt(4)
    s_cmp_eq_u32 s65, 1
    s_cbranch_scc1 L_go204
    s_waitcnt vmcnt(3)
L_go204:
    buffer_load_dwordx4 v[112:115], v91, s[36:39], s48 offen offset:0 nt
    s_waitcnt vmcnt(6)
    s_cmp_eq_u32 s65, 2
    s_cbranch_scc1 L_go205
    s_waitcnt vmcnt(4)
    s_cmp_eq_u32 s65, 1
    s_cbranch_scc1 L_go205
    s_waitcnt vmcnt(3)
L_go205:
    buffer_load_dwordx4 v[116:119], v91, s[36:39], s48 offen offset:1024 nt
    s_waitcnt vmcnt(6)
    s_cmp_eq_u32 s65, 2
    s_cbranch_scc1 L_go206
    s_waitcnt vmcnt(4)
    s_cmp_eq_u32 s65, 1
    s_cbranch_scc1 L_go206
    s_waitcnt vmcnt(3)
L_go206:
    buffer_load_dwordx4 v[120:123], v91, s[36:39], s48 offen offset:2048 nt
    ds_add_u32 v94, v95 offset:20
    v_perm_b32 v46, v244, v240, s46
    v_perm_b32 v47, v252, v248, s46
    v_perm_b32 v62, v246, v242, s46
    v_perm_b32 v63, v254, v250, s46
    v_mfma_f32_16x16x32_bf16 v[4:7], v[44:47], v[12:15], v[4:7]
    v_perm_b32 v50, v248, v244, s47
    v_perm_b32 v51, v240, v252, s47
    v_mfma_f32_16x16x32_bf16 v[8:11], v[60:63], v[12:15], v[8:11]
    v_perm_b32 v66, v250, v246, s47
    v_perm_b32 v67, v242, v254, s47
    v_mfma_f32_16x16x32_bf16 v[4:7], v[48:51], v[16:19], v[4:7]
    s_waitcnt vmcnt(6)
    s_cmp_eq_u32 s65, 2
    s_cbranch_scc1 L_go207
    s_waitcnt vmcnt(4)
    s_cmp_eq_u32 s65, 1
    s_cbranch_scc1 L_go207
    s_waitcnt vmcnt(3)
L_go207:
    buffer_load_dwordx4 v[124:127], v91, s[36:39], s48 offen offset:3072 nt
    s_add_u32 s48, s48, 0x20000
    s_bitset0_b32 s48, 21
    s_waitcnt lgkmcnt(0)
    v_readfirstlane_b32 s66, v80
    v_readfirstlane_b32 s67, v81
    ds_read_b64 v[80:81], v94 offset:24
    s_bitcmp1_b32 s51, 26
    s_cselect_b32 s65, 2, 1
    s_cmpk_gt_i32 s66, 209
    s_cselect_b32 s65, 2, s65
    s_cmpk_gt_i32 s67, 209
    s_cselect_b32 s65, 0, s65
    v_perm_b32 v54, v253, v249, s46
    v_perm_b32 v55, v245, v241, s46
    v_mfma_f32_16x16x32_bf16 v[8:11], v[64:67], v[16:19], v[8:11]
    v_perm_b32 v70, v255, v251, s46
    v_perm_b32 v71, v247, v243, s46
    v_mfma_f32_16x16x32_bf16 v[4:7], v[52:55], v[20:23], v[4:7]
    v_perm_b32 v58, v241, v253, s47
    v_perm_b32 v59, v249, v245, s47
    v_mfma_f32_16x16x32_bf16 v[8:11], v[68:71], v[20:23], v[8:11]
    v_perm_b32 v74, v243, v255, s47
    v_perm_b32 v75, v251, v247, s47
    v_mfma_f32_16x16x32_bf16 v[4:7], v[56:59], v[24:27], v[4:7]
    s_nop 0
    v_mfma_f32_16x16x32_bf16 v[8:11], v[72:75], v[24:27], v[8:11]
    s_waitcnt vmcnt(6)
    s_cmp_eq_u32 s65, 2
    s_cbranch_scc1 L_go208
    s_waitcnt vmcnt(4)
    s_cmp_eq_u32 s65, 1
    s_cbranch_scc1 L_go208
    s_waitcnt vmcnt(3)
L_go208:
    buffer_load_dwordx4 v[128:131], v0, s[36:39], s48 offen offset:0 nt
    v_mov_b32_dpp v78, v37 row_ror:12 row_mask:0xf bank_mask:0xf
    v_perm_b32 v76, v78, v37, s46
    v_perm_b32 v77, v78, v37, s47
    s_nop 0
    v_mov_b32_dpp v12, v76 quad_perm:[0,1,2,3] row_mask:0xf bank_mask:0x1
    v_mov_b32_dpp v13, v76 row_ror:8 row_mask:0xf bank_mask:0x1
    v_mov_b32_dpp v14, v77 quad_perm:[0,1,2,3] row_mask:0xf bank_mask:0x1
    v_mov_b32_dpp v15, v77 row_ror:8 row_mask:0xf bank_mask:0x1
    v_mov_b32_dpp v16, v76 quad_perm:[0,1,2,3] row_mask:0xf bank_mask:0x2
    v_mov_b32_dpp v17, v76 row_ror:8 row_mask:0xf bank_mask:0x2
    v_mov_b32_dpp v18, v77 quad_perm:[0,1,2,3] row_mask:0xf bank_mask:0x2
    v_mov_b32_dpp v19, v77 row_ror:8 row_mask:0xf bank_mask:0x2
    s_waitcnt vmcnt(6)
    s_cmp_eq_u32 s65, 2
    s_cbranch_scc1 L_go209
    s_waitcnt vmcnt(4)
    s_cmp_eq_u32 s65, 1
    s_cbranch_scc1 L_go209
    s_waitcnt vmcnt(3)
L_go209:
    buffer_load_dwordx4 v[132:135], v0, s[36:39], s48 offen offset:1024 nt
    v_mov_b32_dpp v20, v76 quad_perm:[0,1,2,3] row_mask:0xf bank_mask:0x4
    v_mov_b32_dpp v21, v76 row_ror:8 row_mask:0xf bank_mask:0x4
    v_mov_b32_dpp v22, v77 quad_perm:[0,1,2,3] row_mask:0xf bank_mask:0x4
    v_mov_b32_dpp v23, v77 row_ror:8 row_mask:0xf bank_mask:0x4
    v_mov_b32_dpp v24, v76 quad_perm:[0,1,2,3] row_mask:0xf bank_mask:0x8
    v_mov_b32_dpp v25, v76 row_ror:8 row_mask:0xf bank_mask:0x8
    v_mov_b32_dpp v26, v77 quad_perm:[0,1,2,3] row_mask:0xf bank_mask:0x8
    v_mov_b32_dpp v27, v77 row_ror:8 row_mask:0xf bank_mask:0x8
    s_waitcnt vmcnt(6)
    s_cmp_eq_u32 s65, 2
    s_cbranch_scc1 L_go210
    s_waitcnt vmcnt(4)
    s_cmp_eq_u32 s65, 1
    s_cbranch_scc1 L_go210
    s_waitcnt vmcnt(3)
L_go210:
    buffer_load_dwordx4 v[136:139], v0, s[36:39], s48 offen offset:2048 nt
    v_perm_b32 v44, v100, v96, s46
    v_perm_b32 v45, v108, v104, s46
    v_perm_b32 v48, v104, v100, s47
    v_perm_b32 v49, v96, v108, s47
    v_perm_b32 v52, v109, v105, s46
    v_perm_b32 v53, v101, v97, s46
    v_perm_b32 v56, v97, v109, s47
    v_perm_b32 v57, v105, v101, s47
    v_perm_b32 v60, v102, v98, s46
    v_perm_b32 v61, v110, v106, s46
    v_perm_b32 v64, v106, v102, s47
    v_perm_b32 v65, v98, v110, s47
    v_perm_b32 v68, v111, v107, s46
    v_perm_b32 v69, v103, v99, s46
    v_perm_b32 v72, v99, v111, s47
    v_perm_b32 v73, v107, v103, s47
    s_waitcnt vmcnt(6)
    s_cmp_eq_u32 s65, 2
    s_cbranch_scc1 L_go211
    s_waitcnt vmcnt(4)
    s_cmp_eq_u32 s65, 1
    s_cbranch_scc1 L_go211
    s_waitcnt vmcnt(3)
L_go211:
    buffer_load_dwordx4 v[140:143], v0, s[36:39], s48 offen offset:3072 nt
    s_waitcnt lgkmcnt(0)
    v_readfirstlane_b32 s66, v80
    v_readfirstlane_b32 s67, v81
    ds_read_b64 v[80:81], v94 offset:24
    s_bitcmp1_b32 s51, 26
    s_cselect_b32 s65, 2, 1
    s_cmpk_gt_i32 s66, 213
    s_cselect_b32 s65, 2, s65
    s_cmpk_gt_i32 s67, 213
    s_cselect_b32 s65, 0, s65
    s_waitcnt vmcnt(6)
    s_cmp_eq_u32 s65, 2
    s_cbranch_scc1 L_go212
    s_waitcnt vmcnt(4)
    s_cmp_eq_u32 s65, 1
    s_cbranch_scc1 L_go212
    s_waitcnt vmcnt(3)
L_go212:
    buffer_load_dwordx4 v[144:147], v91, s[36:39], s48 offen offset:0 nt
    ds_add_u32 v94, v95 offset:20
    s_waitcnt vmcnt(6)
    s_cmp_eq_u32 s65, 2
    s_cbranch_scc1 L_go213
    s_waitcnt vmcnt(4)
    s_cmp_eq_u32 s65, 1
    s_cbranch_scc1 L_go213
    s_waitcnt vmcnt(3)
L_go213:
    buffer_load_dwordx4 v[148:151], v91, s[36:39], s48 offen offset:1024 nt
    s_waitcnt vmcnt(6)
    s_cmp_eq_u32 s65, 2
    s_cbranch_scc1 L_go214
    s_waitcnt vmcnt(4)
    s_cmp_eq_u32 s65, 1
    s_cbranch_scc1 L_go214
    s_waitcnt vmcnt(3)
L_go214:
    buffer_load_dwordx4 v[152:155], v91, s[36:39], s48 offen offset:2048 nt
    v_perm_b32 v46, v116, v112, s46
    v_perm_b32 v47, v124, v120, s46
    v_perm_b32 v62, v118, v114, s46
    v_perm_b32 v63, v126, v122, s46
    v_mfma_f32_16x16x32_bf16 v[4:7], v[44:47], v[12:15], v[4:7]
    v_perm_b32 v50, v120, v116, s47
    v_perm_b32 v51, v112, v124, s47
    v_mfma_f32_16x16x32_bf16 v[8:11], v[60:63], v[12:15], v[8:11]
    v_perm_b32 v66, v122, v118, s47
    v_perm_b32 v67, v114, v126, s47
    v_mfma_f32_16x16x32_bf16 v[4:7], v[48:51], v[16:19], v[4:7]
    s_waitcnt vmcnt(6)
    s_cmp_eq_u32 s65, 2
    s_cbranch_scc1 L_go215
    s_waitcnt vmcnt(4)
    s_cmp_eq_u32 s65, 1
    s_cbranch_scc1 L_go215
    s_waitcnt vmcnt(3)
L_go215:
    buffer_load_dwordx4 v[156:159], v91, s[36:39], s48 offen offset:3072 nt
    s_add_u32 s48, s48, 0x20000
    s_bitset0_b32 s48, 21
    s_waitcnt lgkmcnt(0)
    v_readfirstlane_b32 s66, v80
    v_readfirstlane_b32 s67, v81
    ds_read_b64 v[80:81], v94 offset:24
    s_bitcmp1_b32 s51, 27
    s_cselect_b32 s65, 2, 1
    s_cmpk_gt_i32 s66, 217
    s_cselect_b32 s65, 2, s65
    s_cmpk_gt_i32 s67, 217
    s_cselect_b32 s65, 0, s65
    v_perm_b32 v54, v125, v121, s46
    v_perm_b32 v55, v117, v113, s46
    v_mfma_f32_16x16x32_bf16 v[8:11], v[64:67], v[16:19], v[8:11]
    v_perm_b32 v70, v127, v123, s46
    v_perm_b32 v71, v119, v115, s46
    v_mfma_f32_16x16x32_bf16 v[4:7], v[52:55], v[20:23], v[4:7]
    v_perm_b32 v58, v113, v125, s47
    v_perm_b32 v59, v121, v117, s47
    v_mfma_f32_16x16x32_bf16 v[8:11], v[68:71], v[20:23], v[8:11]
    v_perm_b32 v74, v115, v127, s47
    v_perm_b32 v75, v123, v119, s47
    v_mfma_f32_16x16x32_bf16 v[4:7], v[56:59], v[24:27], v[4:7]
    s_nop 0
    v_mfma_f32_16x16x32_bf16 v[8:11], v[72:75], v[24:27], v[8:11]
    s_waitcnt vmcnt(6)
    s_cmp_eq_u32 s65, 2
    s_cbranch_scc1 L_go216
    s_waitcnt vmcnt(4)
    s_cmp_eq_u32 s65, 1
    s_cbranch_scc1 L_go216
    s_waitcnt vmcnt(3)
L_go216:
    buffer_load_dwordx4 v[160:163], v0, s[36:39], s48 offen offset:0 nt
    v_mov_b32_dpp v78, v38 row_ror:12 row_mask:0xf bank_mask:0xf
    v_perm_b32 v76, v78, v38, s46
    v_perm_b32 v77, v78, v38, s47
    s_nop 0
    v_mov_b32_dpp v12, v76 quad_perm:[0,1,2,3] row_mask:0xf bank_mask:0x1
    v_mov_b32_dpp v13, v76 row_ror:8 row_mask:0xf bank_mask:0x1
    v_mov_b32_dpp v14, v77 quad_perm:[0,1,2,3] row_mask:0xf bank_mask:0x1
    v_mov_b32_dpp v15, v77 row_ror:8 row_mask:0xf bank_mask:0x1
    v_mov_b32_dpp v16, v76 quad_perm:[0,1,2,3] row_mask:0xf bank_mask:0x2
    v_mov_b32_dpp v17, v76 row_ror:8 row_mask:0xf bank_mask:0x2
    v_mov_b32_dpp v18, v77 quad_perm:[0,1,2,3] row_mask:0xf bank_mask:0x2
    v_mov_b32_dpp v19, v77 row_ror:8 row_mask:0xf bank_mask:0x2
    s_waitcnt vmcnt(6)
    s_cmp_eq_u32 s65, 2
    s_cbranch_scc1 L_go217
    s_waitcnt vmcnt(4)
    s_cmp_eq_u32 s65, 1
    s_cbranch_scc1 L_go217
    s_waitcnt vmcnt(3)
L_go217:
    buffer_load_dwordx4 v[164:167], v0, s[36:39], s48 offen offset:1024 nt
    v_mov_b32_dpp v20, v76 quad_perm:[0,1,2,3] row_mask:0xf bank_mask:0x4
    v_mov_b32_dpp v21, v76 row_ror:8 row_mask:0xf bank_mask:0x4
    v_mov_b32_dpp v22, v77 quad_perm:[0,1,2,3] row_mask:0xf bank_mask:0x4
    v_mov_b32_dpp v23, v77 row_ror:8 row_mask:0xf bank_mask:0x4
    v_mov_b32_dpp v24, v76 quad_perm:[0,1,2,3] row_mask:0xf bank_mask:0x8
    v_mov_b32_dpp v25, v76 row_ror:8 row_mask:0xf bank_mask:0x8
    v_mov_b32_dpp v26, v77 quad_perm:[0,1,2,3] row_mask:0xf bank_mask:0x8
    v_mov_b32_dpp v27, v77 row_ror:8 row_mask:0xf bank_mask:0x8
    s_waitcnt vmcnt(6)
    s_cmp_eq_u32 s65, 2
    s_cbranch_scc1 L_go218
    s_waitcnt vmcnt(4)
    s_cmp_eq_u32 s65, 1
    s_cbranch_scc1 L_go218
    s_waitcnt vmcnt(3)
L_go218:
    buffer_load_dwordx4 v[168:171], v0, s[36:39], s48 offen offset:2048 nt
    v_perm_b32 v44, v132, v128, s46
    v_perm_b32 v45, v140, v136, s46
    v_perm_b32 v48, v136, v132, s47
    v_perm_b32 v49, v128, v140, s47
    v_perm_b32 v52, v141, v137, s46
    v_perm_b32 v53, v133, v129, s46
    v_perm_b32 v56, v129, v141, s47
    v_perm_b32 v57, v137, v133, s47
    v_perm_b32 v60, v134, v130, s46
    v_perm_b32 v61, v142, v138, s46
    v_perm_b32 v64, v138, v134, s47
    v_perm_b32 v65, v130, v142, s47
    v_perm_b32 v68, v143, v139, s46
    v_perm_b32 v69, v135, v131, s46
    v_perm_b32 v72, v131, v143, s47
    v_perm_b32 v73, v139, v135, s47
    s_waitcnt vmcnt(6)
    s_cmp_eq_u32 s65, 2
    s_cbranch_scc1 L_go219
    s_waitcnt vmcnt(4)
    s_cmp_eq_u32 s65, 1
    s_cbranch_scc1 L_go219
    s_waitcnt vmcnt(3)
L_go219:
    buffer_load_dwordx4 v[172:175], v0, s[36:39], s48 offen offset:3072 nt
    s_waitcnt lgkmcnt(0)
    v_readfirstlane_b32 s66, v80
    v_readfirstlane_b32 s67, v81
    ds_read_b64 v[80:81], v94 offset:24
    s_bitcmp1_b32 s51, 27
    s_cselect_b32 s65, 2, 1
    s_cmpk_gt_i32 s66, 221
    s_cselect_b32 s65, 2, s65
    s_cmpk_gt_i32 s67, 221
    s_cselect_b32 s65, 0, s65
    s_waitcnt vmcnt(6)
    s_cmp_eq_u32 s65, 2
    s_cbranch_scc1 L_go220
    s_waitcnt vmcnt(4)
    s_cmp_eq_u32 s65, 1
    s_cbranch_scc1 L_go220
    s_waitcnt vmcnt(3)
L_go220:
    buffer_load_dwordx4 v[176:179], v91, s[36:39], s48 offen offset:0 nt
    s_waitcnt vmcnt(6)
    s_cmp_eq_u32 s65, 2
    s_cbranch_scc1 L_go221
    s_waitcnt vmcnt(4)
    s_cmp_eq_u32 s65, 1
    s_cbranch_scc1 L_go221
    s_waitcnt vmcnt(3)
L_go221:
    buffer_load_dwordx4 v[180:183], v91, s[36:39], s48 offen offset:1024 nt
    s_waitcnt vmcnt(6)
    s_cmp_eq_u32 s65, 2
    s_cbranch_scc1 L_go222
    s_waitcnt vmcnt(4)
    s_cmp_eq_u32 s65, 1
    s_cbranch_scc1 L_go222
    s_waitcnt vmcnt(3)
L_go222:
    buffer_load_dwordx4 v[184:187], v91, s[36:39], s48 offen offset:2048 nt
    v_perm_b32 v46, v148, v144, s46
    v_perm_b32 v47, v156, v152, s46
    v_perm_b32 v62, v150, v146, s46
    v_perm_b32 v63, v158, v154, s46
    v_mfma_f32_16x16x32_bf16 v[4:7], v[44:47], v[12:15], v[4:7]
    v_perm_b32 v50, v152, v148, s47
    v_perm_b32 v51, v144, v156, s47
    v_mfma_f32_16x16x32_bf16 v[8:11], v[60:63], v[12:15], v[8:11]
    v_perm_b32 v66, v154, v150, s47
    v_perm_b32 v67, v146, v158, s47
    v_mfma_f32_16x16x32_bf16 v[4:7], v[48:51], v[16:19], v[4:7]
    s_waitcnt vmcnt(6)
    s_cmp_eq_u32 s65, 2
    s_cbranch_scc1 L_go223
    s_waitcnt vmcnt(4)
    s_cmp_eq_u32 s65, 1
    s_cbranch_scc1 L_go223
    s_waitcnt vmcnt(3)
L_go223:
    buffer_load_dwordx4 v[188:191], v91, s[36:39], s48 offen offset:3072 nt
    s_add_u32 s48, s48, 0x20000
    s_bitset0_b32 s48, 21
    s_waitcnt lgkmcnt(0)
    v_readfirstlane_b32 s66, v80
    v_readfirstlane_b32 s67, v81
    ds_read_b64 v[80:81], v94 offset:24
    s_bitcmp1_b32 s51, 28
    s_cselect_b32 s65, 2, 1
    s_cmpk_gt_i32 s66, 225
    s_cselect_b32 s65, 2, s65
    s_cmpk_gt_i32 s67, 225
    s_cselect_b32 s65, 0, s65
    v_perm_b32 v54, v157, v153, s46
    v_perm_b32 v55, v149, v145, s46
    v_mfma_f32_16x16x32_bf16 v[8:11], v[64:67], v[16:19], v[8:11]
    v_perm_b32 v70, v159, v155, s46
    v_perm_b32 v71, v151, v147, s46
    v_mfma_f32_16x16x32_bf16 v[4:7], v[52:55], v[20:23], v[4:7]
    v_perm_b32 v58, v145, v157, s47
    v_perm_b32 v59, v153, v149, s47
    v_mfma_f32_16x16x32_bf16 v[8:11], v[68:71], v[20:23], v[8:11]
    v_perm_b32 v74, v147, v159, s47
    v_perm_b32 v75, v155, v151, s47
    v_mfma_f32_16x16x32_bf16 v[4:7], v[56:59], v[24:27], v[4:7]
    s_nop 0
    v_mfma_f32_16x16x32_bf16 v[8:11], v[72:75], v[24:27], v[8:11]
    s_waitcnt vmcnt(6)
    s_cmp_eq_u32 s65, 2
    s_cbranch_scc1 L_go224
    s_waitcnt vmcnt(4)
    s_cmp_eq_u32 s65, 1
    s_cbranch_scc1 L_go224
    s_waitcnt vmcnt(3)
L_go224:
    buffer_load_dwordx4 v[192:195], v0, s[36:39], s48 offen offset:0 nt
    v_mov_b32_dpp v78, v39 row_ror:12 row_mask:0xf bank_mask:0xf
    v_perm_b32 v76, v78, v39, s46
    v_perm_b32 v77, v78, v39, s47
    s_nop 0
    v_mov_b32_dpp v12, v76 quad_perm:[0,1,2,3] row_mask:0xf bank_mask:0x1
    v_mov_b32_dpp v13, v76 row_ror:8 row_mask:0xf bank_mask:0x1
    v_mov_b32_dpp v14, v77 quad_perm:[0,1,2,3] row_mask:0xf bank_mask:0x1
    v_mov_b32_dpp v15, v77 row_ror:8 row_mask:0xf bank_mask:0x1
    v_mov_b32_dpp v16, v76 quad_perm:[0,1,2,3] row_mask:0xf bank_mask:0x2
    v_mov_b32_dpp v17, v76 row_ror:8 row_mask:0xf bank_mask:0x2
    v_mov_b32_dpp v18, v77 quad_perm:[0,1,2,3] row_mask:0xf bank_mask:0x2
    v_mov_b32_dpp v19, v77 row_ror:8 row_mask:0xf bank_mask:0x2
    s_waitcnt vmcnt(6)
    s_cmp_eq_u32 s65, 2
    s_cbranch_scc1 L_go225
    s_waitcnt vmcnt(4)
    s_cmp_eq_u32 s65, 1
    s_cbranch_scc1 L_go225
    s_waitcnt vmcnt(3)
L_go225:
    buffer_load_dwordx4 v[196:199], v0, s[36:39], s48 offen offset:1024 nt
    v_mov_b32_dpp v20, v76 quad_perm:[0,1,2,3] row_mask:0xf bank_mask:0x4
    v_mov_b32_dpp v21, v76 row_ror:8 row_mask:0xf bank_mask:0x4
    v_mov_b32_dpp v22, v77 quad_perm:[0,1,2,3] row_mask:0xf bank_mask:0x4
    v_mov_b32_dpp v23, v77 row_ror:8 row_mask:0xf bank_mask:0x4
    v_mov_b32_dpp v24, v76 quad_perm:[0,1,2,3] row_mask:0xf bank_mask:0x8
    v_mov_b32_dpp v25, v76 row_ror:8 row_mask:0xf bank_mask:0x8
    v_mov_b32_dpp v26, v77 quad_perm:[0,1,2,3] row_mask:0xf bank_mask:0x8
    v_mov_b32_dpp v27, v77 row_ror:8 row_mask:0xf bank_mask:0x8
    s_waitcnt vmcnt(6)
    s_cmp_eq_u32 s65, 2
    s_cbranch_scc1 L_go226
    s_waitcnt vmcnt(4)
    s_cmp_eq_u32 s65, 1
    s_cbranch_scc1 L_go226
    s_waitcnt vmcnt(3)
L_go226:
    buffer_load_dwordx4 v[200:203], v0, s[36:39], s48 offen offset:2048 nt
    v_perm_b32 v44, v164, v160, s46
    v_perm_b32 v45, v172, v168, s46
    v_perm_b32 v48, v168, v164, s47
    v_perm_b32 v49, v160, v172, s47
    v_perm_b32 v52, v173, v169, s46
    v_perm_b32 v53, v165, v161, s46
    v_perm_b32 v56, v161, v173, s47
    v_perm_b32 v57, v169, v165, s47
    v_perm_b32 v60, v166, v162, s46
    v_perm_b32 v61, v174, v170, s46
    v_perm_b32 v64, v170, v166, s47
    v_perm_b32 v65, v162, v174, s47
    v_perm_b32 v68, v175, v171, s46
    v_perm_b32 v69, v167, v163, s46
    v_perm_b32 v72, v163, v175, s47
    v_perm_b32 v73, v171, v167, s47
    s_waitcnt vmcnt(6)
    s_cmp_eq_u32 s65, 2
    s_cbranch_scc1 L_go227
    s_waitcnt vmcnt(4)
    s_cmp_eq_u32 s65, 1
    s_cbranch_scc1 L_go227
    s_waitcnt vmcnt(3)
L_go227:
    buffer_load_dwordx4 v[204:207], v0, s[36:39], s48 offen offset:3072 nt
    s_waitcnt lgkmcnt(0)
    v_readfirstlane_b32 s66, v80
    v_readfirstlane_b32 s67, v81
    ds_read_b64 v[80:81], v94 offset:24
    s_bitcmp1_b32 s51, 28
    s_cselect_b32 s65, 2, 1
    s_cmpk_gt_i32 s66, 229
    s_cselect_b32 s65, 2, s65
    s_cmpk_gt_i32 s67, 229
    s_cselect_b32 s65, 0, s65
    s_waitcnt vmcnt(6)
    s_cmp_eq_u32 s65, 2
    s_cbranch_scc1 L_go228
    s_waitcnt vmcnt(4)
    s_cmp_eq_u32 s65, 1
    s_cbranch_scc1 L_go228
    s_waitcnt vmcnt(3)
L_go228:
    buffer_load_dwordx4 v[208:211], v91, s[36:39], s48 offen offset:0 nt
    s_waitcnt vmcnt(6)
    s_cmp_eq_u32 s65, 2
    s_cbranch_scc1 L_go229
    s_waitcnt vmcnt(4)
    s_cmp_eq_u32 s65, 1
    s_cbranch_scc1 L_go229
    s_waitcnt vmcnt(3)
L_go229:
    buffer_load_dwordx4 v[212:215], v91, s[36:39], s48 offen offset:1024 nt
    s_waitcnt vmcnt(6)
    s_cmp_eq_u32 s65, 2
    s_cbranch_scc1 L_go230
    s_waitcnt vmcnt(4)
    s_cmp_eq_u32 s65, 1
    s_cbranch_scc1 L_go230
    s_waitcnt vmcnt(3)
L_go230:
    buffer_load_dwordx4 v[216:219], v91, s[36:39], s48 offen offset:2048 nt
    v_perm_b32 v46, v180, v176, s46
    v_perm_b32 v47, v188, v184, s46
    v_perm_b32 v62, v182, v178, s46
    v_perm_b32 v63, v190, v186, s46
    v_mfma_f32_16x16x32_bf16 v[4:7], v[44:47], v[12:15], v[4:7]
    v_perm_b32 v50, v184, v180, s47
    v_perm_b32 v51, v176, v188, s47
    v_mfma_f32_16x16x32_bf16 v[8:11], v[60:63], v[12:15], v[8:11]
    v_perm_b32 v66, v186, v182, s47
    v_perm_b32 v67, v178, v190, s47
    v_mfma_f32_16x16x32_bf16 v[4:7], v[48:51], v[16:19], v[4:7]
    s_waitcnt vmcnt(6)
    s_cmp_eq_u32 s65, 2
    s_cbranch_scc1 L_go231
    s_waitcnt vmcnt(4)
    s_cmp_eq_u32 s65, 1
    s_cbranch_scc1 L_go231
    s_waitcnt vmcnt(3)
L_go231:
    buffer_load_dwordx4 v[220:223], v91, s[36:39], s48 offen offset:3072 nt
    s_add_u32 s48, s48, 0x20000
    s_bitset0_b32 s48, 21
    s_waitcnt lgkmcnt(0)
    v_readfirstlane_b32 s66, v80
    v_readfirstlane_b32 s67, v81
    ds_read_b64 v[80:81], v94 offset:24
    s_bitcmp1_b32 s51, 29
    s_cselect_b32 s65, 2, 1
    s_cmpk_gt_i32 s66, 233
    s_cselect_b32 s65, 2, s65
    s_cmpk_gt_i32 s67, 233
    s_cselect_b32 s65, 0, s65
    v_perm_b32 v54, v189, v185, s46
    v_perm_b32 v55, v181, v177, s46
    v_mfma_f32_16x16x32_bf16 v[8:11], v[64:67], v[16:19], v[8:11]
    v_perm_b32 v70, v191, v187, s46
    v_perm_b32 v71, v183, v179, s46
    v_mfma_f32_16x16x32_bf16 v[4:7], v[52:55], v[20:23], v[4:7]
    v_perm_b32 v58, v177, v189, s47
    v_perm_b32 v59, v185, v181, s47
    v_mfma_f32_16x16x32_bf16 v[8:11], v[68:71], v[20:23], v[8:11]
    v_perm_b32 v74, v179, v191, s47
    v_perm_b32 v75, v187, v183, s47
    v_mfma_f32_16x16x32_bf16 v[4:7], v[56:59], v[24:27], v[4:7]
    s_nop 0
    v_mfma_f32_16x16x32_bf16 v[8:11], v[72:75], v[24:27], v[8:11]
    s_waitcnt vmcnt(6)
    s_cmp_eq_u32 s65, 2
    s_cbranch_scc1 L_go232
    s_waitcnt vmcnt(4)
    s_cmp_eq_u32 s65, 1
    s_cbranch_scc1 L_go232
    s_waitcnt vmcnt(3)
L_go232:
    buffer_load_dwordx4 v[224:227], v0, s[36:39], s48 offen offset:0 nt
    v_mov_b32_dpp v78, v40 row_ror:12 row_mask:0xf bank_mask:0xf
    v_perm_b32 v76, v78, v40, s46
    v_perm_b32 v77, v78, v40, s47
    s_nop 0
    v_mov_b32_dpp v12, v76 quad_perm:[0,1,2,3] row_mask:0xf bank_mask:0x1
    v_mov_b32_dpp v13, v76 row_ror:8 row_mask:0xf bank_mask:0x1
    v_mov_b32_dpp v14, v77 quad_perm:[0,1,2,3] row_mask:0xf bank_mask:0x1
    v_mov_b32_dpp v15, v77 row_ror:8 row_mask:0xf bank_mask:0x1
    v_mov_b32_dpp v16, v76 quad_perm:[0,1,2,3] row_mask:0xf bank_mask:0x2
    v_mov_b32_dpp v17, v76 row_ror:8 row_mask:0xf bank_mask:0x2
    v_mov_b32_dpp v18, v77 quad_perm:[0,1,2,3] row_mask:0xf bank_mask:0x2
    v_mov_b32_dpp v19, v77 row_ror:8 row_mask:0xf bank_mask:0x2
    s_waitcnt vmcnt(6)
    s_cmp_eq_u32 s65, 2
    s_cbranch_scc1 L_go233
    s_waitcnt vmcnt(4)
    s_cmp_eq_u32 s65, 1
    s_cbranch_scc1 L_go233
    s_waitcnt vmcnt(3)
L_go233:
    buffer_load_dwordx4 v[228:231], v0, s[36:39], s48 offen offset:1024 nt
    v_mov_b32_dpp v20, v76 quad_perm:[0,1,2,3] row_mask:0xf bank_mask:0x4
    v_mov_b32_dpp v21, v76 row_ror:8 row_mask:0xf bank_mask:0x4
    v_mov_b32_dpp v22, v77 quad_perm:[0,1,2,3] row_mask:0xf bank_mask:0x4
    v_mov_b32_dpp v23, v77 row_ror:8 row_mask:0xf bank_mask:0x4
    v_mov_b32_dpp v24, v76 quad_perm:[0,1,2,3] row_mask:0xf bank_mask:0x8
    v_mov_b32_dpp v25, v76 row_ror:8 row_mask:0xf bank_mask:0x8
    v_mov_b32_dpp v26, v77 quad_perm:[0,1,2,3] row_mask:0xf bank_mask:0x8
    v_mov_b32_dpp v27, v77 row_ror:8 row_mask:0xf bank_mask:0x8
    s_waitcnt vmcnt(6)
    s_cmp_eq_u32 s65, 2
    s_cbranch_scc1 L_go234
    s_waitcnt vmcnt(4)
    s_cmp_eq_u32 s65, 1
    s_cbranch_scc1 L_go234
    s_waitcnt vmcnt(3)
L_go234:
    buffer_load_dwordx4 v[232:235], v0, s[36:39], s48 offen offset:2048 nt
    v_perm_b32 v44, v196, v192, s46
    v_perm_b32 v45, v204, v200, s46
    v_perm_b32 v48, v200, v196, s47
    v_perm_b32 v49, v192, v204, s47
    v_perm_b32 v52, v205, v201, s46
    v_perm_b32 v53, v197, v193, s46
    v_perm_b32 v56, v193, v205, s47
    v_perm_b32 v57, v201, v197, s47
    v_perm_b32 v60, v198, v194, s46
    v_perm_b32 v61, v206, v202, s46
    v_perm_b32 v64, v202, v198, s47
    v_perm_b32 v65, v194, v206, s47
    v_perm_b32 v68, v207, v203, s46
    v_perm_b32 v69, v199, v195, s46
    v_perm_b32 v72, v195, v207, s47
    v_perm_b32 v73, v203, v199, s47
    s_waitcnt vmcnt(6)
    s_cmp_eq_u32 s65, 2
    s_cbranch_scc1 L_go235
    s_waitcnt vmcnt(4)
    s_cmp_eq_u32 s65, 1
    s_cbranch_scc1 L_go235
    s_waitcnt vmcnt(3)
L_go235:
    buffer_load_dwordx4 v[236:239], v0, s[36:39], s48 offen offset:3072 nt
    s_waitcnt lgkmcnt(0)
    v_readfirstlane_b32 s66, v80
    v_readfirstlane_b32 s67, v81
    ds_read_b64 v[80:81], v94 offset:24
    s_bitcmp1_b32 s51, 29
    s_cselect_b32 s65, 2, 1
    s_cmpk_gt_i32 s66, 237
    s_cselect_b32 s65, 2, s65
    s_cmpk_gt_i32 s67, 237
    s_cselect_b32 s65, 0, s65
    s_waitcnt vmcnt(6)
    s_cmp_eq_u32 s65, 2
    s_cbranch_scc1 L_go236
    s_waitcnt vmcnt(4)
    s_cmp_eq_u32 s65, 1
    s_cbranch_scc1 L_go236
    s_waitcnt vmcnt(3)
L_go236:
    buffer_load_dwordx4 v[240:243], v91, s[36:39], s48 offen offset:0 nt
    s_waitcnt vmcnt(6)
    s_cmp_eq_u32 s65, 2
    s_cbranch_scc1 L_go237
    s_waitcnt vmcnt(4)
    s_cmp_eq_u32 s65, 1
    s_cbranch_scc1 L_go237
    s_waitcnt vmcnt(3)
L_go237:
    buffer_load_dwordx4 v[244:247], v91, s[36:39], s48 offen offset:1024 nt
    s_waitcnt vmcnt(6)
    s_cmp_eq_u32 s65, 2
    s_cbranch_scc1 L_go238
    s_waitcnt vmcnt(4)
    s_cmp_eq_u32 s65, 1
    s_cbranch_scc1 L_go238
    s_waitcnt vmcnt(3)
L_go238:
    buffer_load_dwordx4 v[248:251], v91, s[36:39], s48 offen offset:2048 nt
    v_perm_b32 v46, v212, v208, s46
    v_perm_b32 v47, v220, v216, s46
    v_perm_b32 v62, v214, v210, s46
    v_perm_b32 v63, v222, v218, s46
    v_mfma_f32_16x16x32_bf16 v[4:7], v[44:47], v[12:15], v[4:7]
    v_perm_b32 v50, v216, v212, s47
    v_perm_b32 v51, v208, v220, s47
    v_mfma_f32_16x16x32_bf16 v[8:11], v[60:63], v[12:15], v[8:11]
    v_perm_b32 v66, v218, v214, s47
    v_perm_b32 v67, v210, v222, s47
    v_mfma_f32_16x16x32_bf16 v[4:7], v[48:51], v[16:19], v[4:7]
    s_waitcnt vmcnt(6)
    s_cmp_eq_u32 s65, 2
    s_cbranch_scc1 L_go239
    s_waitcnt vmcnt(4)
    s_cmp_eq_u32 s65, 1
    s_cbranch_scc1 L_go239
    s_waitcnt vmcnt(3)
L_go239:
    buffer_load_dwordx4 v[252:255], v91, s[36:39], s48 offen offset:3072 nt
    s_add_u32 s48, s48, 0x20000
    s_bitset0_b32 s48, 21
    v_perm_b32 v54, v221, v217, s46
    v_perm_b32 v55, v213, v209, s46
    v_mfma_f32_16x16x32_bf16 v[8:11], v[64:67], v[16:19], v[8:11]
    v_perm_b32 v70, v223, v219, s46
    v_perm_b32 v71, v215, v211, s46
    v_mfma_f32_16x16x32_bf16 v[4:7], v[52:55], v[20:23], v[4:7]
    v_perm_b32 v58, v209, v221, s47
    v_perm_b32 v59, v217, v213, s47
    v_mfma_f32_16x16x32_bf16 v[8:11], v[68:71], v[20:23], v[8:11]
    v_perm_b32 v74, v211, v223, s47
    v_perm_b32 v75, v219, v215, s47
    v_mfma_f32_16x16x32_bf16 v[4:7], v[56:59], v[24:27], v[4:7]
    s_nop 0
    v_mfma_f32_16x16x32_bf16 v[8:11], v[72:75], v[24:27], v[8:11]
    s_waitcnt vmcnt(6)
    buffer_load_dwordx4 v[96:99], v0, s[36:39], s48 offen offset:0 nt
    v_mov_b32_dpp v78, v41 row_ror:12 row_mask:0xf bank_mask:0xf
    v_perm_b32 v76, v78, v41, s46
    v_perm_b32 v77, v78, v41, s47
    s_nop 0
    v_mov_b32_dpp v12, v76 quad_perm:[0,1,2,3] row_mask:0xf bank_mask:0x1
    v_mov_b32_dpp v13, v76 row_ror:8 row_mask:0xf bank_mask:0x1
    v_mov_b32_dpp v14, v77 quad_perm:[0,1,2,3] row_mask:0xf bank_mask:0x1
    v_mov_b32_dpp v15, v77 row_ror:8 row_mask:0xf bank_mask:0x1
    v_mov_b32_dpp v16, v76 quad_perm:[0,1,2,3] row_mask:0xf bank_mask:0x2
    v_mov_b32_dpp v17, v76 row_ror:8 row_mask:0xf bank_mask:0x2
    v_mov_b32_dpp v18, v77 quad_perm:[0,1,2,3] row_mask:0xf bank_mask:0x2
    v_mov_b32_dpp v19, v77 row_ror:8 row_mask:0xf bank_mask:0x2
    s_waitcnt vmcnt(6)
    buffer_load_dwordx4 v[100:103], v0, s[36:39], s48 offen offset:1024 nt
    v_mov_b32_dpp v20, v76 quad_perm:[0,1,2,3] row_mask:0xf bank_mask:0x4
    v_mov_b32_dpp v21, v76 row_ror:8 row_mask:0xf bank_mask:0x4
    v_mov_b32_dpp v22, v77 quad_perm:[0,1,2,3] row_mask:0xf bank_mask:0x4
    v_mov_b32_dpp v23, v77 row_ror:8 row_mask:0xf bank_mask:0x4
    v_mov_b32_dpp v24, v76 quad_perm:[0,1,2,3] row_mask:0xf bank_mask:0x8
    v_mov_b32_dpp v25, v76 row_ror:8 row_mask:0xf bank_mask:0x8
    v_mov_b32_dpp v26, v77 quad_perm:[0,1,2,3] row_mask:0xf bank_mask:0x8
    v_mov_b32_dpp v27, v77 row_ror:8 row_mask:0xf bank_mask:0x8
    s_waitcnt vmcnt(6)
    buffer_load_dwordx4 v[104:107], v0, s[36:39], s48 offen offset:2048 nt
    v_perm_b32 v44, v228, v224, s46
    v_perm_b32 v45, v236, v232, s46
    v_perm_b32 v48, v232, v228, s47
    v_perm_b32 v49, v224, v236, s47
    v_perm_b32 v52, v237, v233, s46
    v_perm_b32 v53, v229, v225, s46
    v_perm_b32 v56, v225, v237, s47
    v_perm_b32 v57, v233, v229, s47
    v_perm_b32 v60, v230, v226, s46
    v_perm_b32 v61, v238, v234, s46
    v_perm_b32 v64, v234, v230, s47
    v_perm_b32 v65, v226, v238, s47
    v_perm_b32 v68, v239, v235, s46
    v_perm_b32 v69, v231, v227, s46
    v_perm_b32 v72, v227, v239, s47
    v_perm_b32 v73, v235, v231, s47
    s_waitcnt vmcnt(6)
    buffer_load_dwordx4 v[108:111], v0, s[36:39], s48 offen offset:3072 nt
    s_waitcnt vmcnt(6)
    buffer_load_dwordx4 v[112:115], v91, s[36:39], s48 offen offset:0 nt
    s_waitcnt vmcnt(6)
    buffer_load_dwordx4 v[116:119], v91, s[36:39], s48 offen offset:1024 nt
    s_waitcnt vmcnt(6)
    buffer_load_dwordx4 v[120:123], v91, s[36:39], s48 offen offset:2048 nt
    v_perm_b32 v46, v244, v240, s46
    v_perm_b32 v47, v252, v248, s46
    v_perm_b32 v62, v246, v242, s46
    v_perm_b32 v63, v254, v250, s46
    v_mfma_f32_16x16x32_bf16 v[4:7], v[44:47], v[12:15], v[4:7]
    v_perm_b32 v50, v248, v244, s47
    v_perm_b32 v51, v240, v252, s47
    v_mfma_f32_16x16x32_bf16 v[8:11], v[60:63], v[12:15], v[8:11]
    v_perm_b32 v66, v250, v246, s47
    v_perm_b32 v67, v242, v254, s47
    v_mfma_f32_16x16x32_bf16 v[4:7], v[48:51], v[16:19], v[4:7]
    s_waitcnt vmcnt(6)
    buffer_load_dwordx4 v[124:127], v91, s[36:39], s48 offen offset:3072 nt
    s_add_u32 s48, s48, 0x20000
    s_bitset0_b32 s48, 21
    v_perm_b32 v54, v253, v249, s46
    v_perm_b32 v55, v245, v241, s46
    v_mfma_f32_16x16x32_bf16 v[8:11], v[64:67], v[16:19], v[8:11]
    v_perm_b32 v70, v255, v251, s46
    v_perm_b32 v71, v247, v243, s46
    v_mfma_f32_16x16x32_bf16 v[4:7], v[52:55], v[20:23], v[4:7]
    v_perm_b32 v58, v241, v253, s47
    v_perm_b32 v59, v249, v245, s47
    v_mfma_f32_16x16x32_bf16 v[8:11], v[68:71], v[20:23], v[8:11]
    v_perm_b32 v74, v243, v255, s47
    v_perm_b32 v75, v251, v247, s47
    v_mfma_f32_16x16x32_bf16 v[4:7], v[56:59], v[24:27], v[4:7]
    s_nop 0
    v_mfma_f32_16x16x32_bf16 v[8:11], v[72:75], v[24:27], v[8:11]
    s_waitcnt vmcnt(6)
    buffer_load_dwordx4 v[128:131], v0, s[36:39], s48 offen offset:0 nt
    v_mov_b32_dpp v78, v42 row_ror:12 row_mask:0xf bank_mask:0xf
    v_perm_b32 v76, v78, v42, s46
    v_perm_b32 v77, v78, v42, s47
    s_nop 0
    v_mov_b32_dpp v12, v76 quad_perm:[0,1,2,3] row_mask:0xf bank_mask:0x1
    v_mov_b32_dpp v13, v76 row_ror:8 row_mask:0xf bank_mask:0x1
    v_mov_b32_dpp v14, v77 quad_perm:[0,1,2,3] row_mask:0xf bank_mask:0x1
    v_mov_b32_dpp v15, v77 row_ror:8 row_mask:0xf bank_mask:0x1
    v_mov_b32_dpp v16, v76 quad_perm:[0,1,2,3] row_mask:0xf bank_mask:0x2
    v_mov_b32_dpp v17, v76 row_ror:8 row_mask:0xf bank_mask:0x2
    v_mov_b32_dpp v18, v77 quad_perm:[0,1,2,3] row_mask:0xf bank_mask:0x2
    v_mov_b32_dpp v19, v77 row_ror:8 row_mask:0xf bank_mask:0x2
    s_waitcnt vmcnt(6)
    buffer_load_dwordx4 v[132:135], v0, s[36:39], s48 offen offset:1024 nt
    v_mov_b32_dpp v20, v76 quad_perm:[0,1,2,3] row_mask:0xf bank_mask:0x4
    v_mov_b32_dpp v21, v76 row_ror:8 row_mask:0xf bank_mask:0x4
    v_mov_b32_dpp v22, v77 quad_perm:[0,1,2,3] row_mask:0xf bank_mask:0x4
    v_mov_b32_dpp v23, v77 row_ror:8 row_mask:0xf bank_mask:0x4
    v_mov_b32_dpp v24, v76 quad_perm:[0,1,2,3] row_mask:0xf bank_mask:0x8
    v_mov_b32_dpp v25, v76 row_ror:8 row_mask:0xf bank_mask:0x8
    v_mov_b32_dpp v26, v77 quad_perm:[0,1,2,3] row_mask:0xf bank_mask:0x8
    v_mov_b32_dpp v27, v77 row_ror:8 row_mask:0xf bank_mask:0x8
    s_waitcnt vmcnt(6)
    buffer_load_dwordx4 v[136:139], v0, s[36:39], s48 offen offset:2048 nt
    v_perm_b32 v44, v100, v96, s46
    v_perm_b32 v45, v108, v104, s46
    v_perm_b32 v48, v104, v100, s47
    v_perm_b32 v49, v96, v108, s47
    v_perm_b32 v52, v109, v105, s46
    v_perm_b32 v53, v101, v97, s46
    v_perm_b32 v56, v97, v109, s47
    v_perm_b32 v57, v105, v101, s47
    v_perm_b32 v60, v102, v98, s46
    v_perm_b32 v61, v110, v106, s46
    v_perm_b32 v64, v106, v102, s47
    v_perm_b32 v65, v98, v110, s47
    v_perm_b32 v68, v111, v107, s46
    v_perm_b32 v69, v103, v99, s46
    v_perm_b32 v72, v99, v111, s47
    v_perm_b32 v73, v107, v103, s47
    s_waitcnt vmcnt(6)
    buffer_load_dwordx4 v[140:143], v0, s[36:39], s48 offen offset:3072 nt
    s_waitcnt vmcnt(6)
    buffer_load_dwordx4 v[144:147], v91, s[36:39], s48 offen offset:0 nt
    s_waitcnt vmcnt(6)
    buffer_load_dwordx4 v[148:151], v91, s[36:39], s48 offen offset:1024 nt
    s_waitcnt vmcnt(6)
    buffer_load_dwordx4 v[152:155], v91, s[36:39], s48 offen offset:2048 nt
    v_perm_b32 v46, v116, v112, s46
    v_perm_b32 v47, v124, v120, s46
    v_perm_b32 v62, v118, v114, s46
    v_perm_b32 v63, v126, v122, s46
    v_mfma_f32_16x16x32_bf16 v[4:7], v[44:47], v[12:15], v[4:7]
    v_perm_b32 v50, v120, v116, s47
    v_perm_b32 v51, v112, v124, s47
    v_mfma_f32_16x16x32_bf16 v[8:11], v[60:63], v[12:15], v[8:11]
    v_perm_b32 v66, v122, v118, s47
    v_perm_b32 v67, v114, v126, s47
    v_mfma_f32_16x16x32_bf16 v[4:7], v[48:51], v[16:19], v[4:7]
    s_waitcnt vmcnt(6)
    buffer_load_dwordx4 v[156:159], v91, s[36:39], s48 offen offset:3072 nt
    v_perm_b32 v54, v125, v121, s46
    v_perm_b32 v55, v117, v113, s46
    v_mfma_f32_16x16x32_bf16 v[8:11], v[64:67], v[16:19], v[8:11]
    v_perm_b32 v70, v127, v123, s46
    v_perm_b32 v71, v119, v115, s46
    v_mfma_f32_16x16x32_bf16 v[4:7], v[52:55], v[20:23], v[4:7]
    v_perm_b32 v58, v113, v125, s47
    v_perm_b32 v59, v121, v117, s47
    v_mfma_f32_16x16x32_bf16 v[8:11], v[68:71], v[20:23], v[8:11]
    v_perm_b32 v74, v115, v127, s47
    v_perm_b32 v75, v123, v119, s47
    v_mfma_f32_16x16x32_bf16 v[4:7], v[56:59], v[24:27], v[4:7]
    s_nop 0
    v_mfma_f32_16x16x32_bf16 v[8:11], v[72:75], v[24:27], v[8:11]
    v_mov_b32_dpp v78, v43 row_ror:12 row_mask:0xf bank_mask:0xf
    v_perm_b32 v76, v78, v43, s46
    v_perm_b32 v77, v78, v43, s47
    s_nop 0
    v_mov_b32_dpp v12, v76 quad_perm:[0,1,2,3] row_mask:0xf bank_mask:0x1
    v_mov_b32_dpp v13, v76 row_ror:8 row_mask:0xf bank_mask:0x1
    v_mov_b32_dpp v14, v77 quad_perm:[0,1,2,3] row_mask:0xf bank_mask:0x1
    v_mov_b32_dpp v15, v77 row_ror:8 row_mask:0xf bank_mask:0x1
    v_mov_b32_dpp v16, v76 quad_perm:[0,1,2,3] row_mask:0xf bank_mask:0x2
    v_mov_b32_dpp v17, v76 row_ror:8 row_mask:0xf bank_mask:0x2
    v_mov_b32_dpp v18, v77 quad_perm:[0,1,2,3] row_mask:0xf bank_mask:0x2
    v_mov_b32_dpp v19, v77 row_ror:8 row_mask:0xf bank_mask:0x2
    v_mov_b32_dpp v20, v76 quad_perm:[0,1,2,3] row_mask:0xf bank_mask:0x4
    v_mov_b32_dpp v21, v76 row_ror:8 row_mask:0xf bank_mask:0x4
    v_mov_b32_dpp v22, v77 quad_perm:[0,1,2,3] row_mask:0xf bank_mask:0x4
    v_mov_b32_dpp v23, v77 row_ror:8 row_mask:0xf bank_mask:0x4
    v_mov_b32_dpp v24, v76 quad_perm:[0,1,2,3] row_mask:0xf bank_mask:0x8
    v_mov_b32_dpp v25, v76 row_ror:8 row_mask:0xf bank_mask:0x8
    v_mov_b32_dpp v26, v77 quad_perm:[0,1,2,3] row_mask:0xf bank_mask:0x8
    v_mov_b32_dpp v27, v77 row_ror:8 row_mask:0xf bank_mask:0x8
    s_waitcnt vmcnt(4)
    v_perm_b32 v44, v132, v128, s46
    v_perm_b32 v45, v140, v136, s46
    v_perm_b32 v48, v136, v132, s47
    v_perm_b32 v49, v128, v140, s47
    v_perm_b32 v52, v141, v137, s46
    v_perm_b32 v53, v133, v129, s46
    v_perm_b32 v56, v129, v141, s47
    v_perm_b32 v57, v137, v133, s47
    v_perm_b32 v60, v134, v130, s46
    v_perm_b32 v61, v142, v138, s46
    v_perm_b32 v64, v138, v134, s47
    v_perm_b32 v65, v130, v142, s47
    v_perm_b32 v68, v143, v139, s46
    v_perm_b32 v69, v135, v131, s46
    v_perm_b32 v72, v131, v143, s47
    v_perm_b32 v73, v139, v135, s47
    s_waitcnt vmcnt(0)
    v_perm_b32 v46, v148, v144, s46
    v_perm_b32 v47, v156, v152, s46
    v_perm_b32 v62, v150, v146, s46
    v_perm_b32 v63, v158, v154, s46
    v_mfma_f32_16x16x32_bf16 v[4:7], v[44:47], v[12:15], v[4:7]
    v_perm_b32 v50, v152, v148, s47
    v_perm_b32 v51, v144, v156, s47
    v_mfma_f32_16x16x32_bf16 v[8:11], v[60:63], v[12:15], v[8:11]
    v_perm_b32 v66, v154, v150, s47
    v_perm_b32 v67, v146, v158, s47
    v_mfma_f32_16x16x32_bf16 v[4:7], v[48:51], v[16:19], v[4:7]
    v_perm_b32 v54, v157, v153, s46
    v_perm_b32 v55, v149, v145, s46
    v_mfma_f32_16x16x32_bf16 v[8:11], v[64:67], v[16:19], v[8:11]
    v_perm_b32 v70, v159, v155, s46
    v_perm_b32 v71, v151, v147, s46
    v_mfma_f32_16x16x32_bf16 v[4:7], v[52:55], v[20:23], v[4:7]
    v_perm_b32 v58, v145, v157, s47
    v_perm_b32 v59, v153, v149, s47
    v_mfma_f32_16x16x32_bf16 v[8:11], v[68:71], v[20:23], v[8:11]
    v_perm_b32 v74, v147, v159, s47
    v_perm_b32 v75, v155, v151, s47
    v_mfma_f32_16x16x32_bf16 v[4:7], v[56:59], v[24:27], v[4:7]
    s_nop 0
    v_mfma_f32_16x16x32_bf16 v[8:11], v[72:75], v[24:27], v[8:11]
    s_nop 5
    ds_write_b128 v92, v[4:7]
    s_nop 0
    ds_write_b128 v92, v[8:11] offset:1024
    s_waitcnt lgkmcnt(0)
    s_barrier
    s_cmp_eq_u32 s61, 2
    s_cbranch_scc1 L_st2
    s_branch L_fin
L_st1:
    s_and_b32 s56, s62, 7
    s_lshr_b32 s57, s62, 3
    s_and_b32 s55, s3, 3
    v_lshrrev_b32 v86, 4, v1
    v_lshlrev_b32 v86, 11, v86
    v_and_b32 v87, 15, v1
    v_lshl_add_u32 v86, v87, 4, v86
    s_lshl_b32 s52, s4, 16
    s_add_u32 s52, s52, 65536
    s_lshl_b32 s53, s55, 8
    s_add_u32 s52, s52, s53
    s_lshl_b32 s53, s57, 10
    s_add_u32 s52, s52, s53
    s_lshl_b32 s53, s56, 13
    s_add_u32 s52, s52, s53
    v_add_u32 v44, s52, v86
    v_xor_b32 v45, 8192, v44
    v_xor_b32 v46, 16384, v44
    v_xor_b32 v47, 24576, v44
    v_xor_b32 v48, 32768, v44
    v_xor_b32 v49, 40960, v44
    v_xor_b32 v50, 49152, v44
    v_xor_b32 v51, 57344, v44
    v_mov_b32 v84, 79088
    ds_read_b32 v84, v84
    v_mov_b32 v93, 0xffffff00
    s_waitcnt lgkmcnt(0)
    v_readfirstlane_b32 s60, v84
    s_nop 0
    s_bfe_u32 s76, s60, 0x80000
    s_bfe_u32 s77, s60, 0x80008
    s_bfe_u32 s78, s60, 0x80010
    s_bfe_u32 s79, s60, 0x80018
    v_bfe_u32 v84, v1, 3, 1
    v_lshlrev_b32 v84, 13, v84
    v_lshrrev_b32 v85, 4, v1
    v_lshl_add_u32 v84, v85, 9, v84
    v_and_b32 v85, 7, v1
    v_lshl_add_u32 v84, v85, 4, v84
    s_lshl_b32 s52, s55, 11
    v_add_u32 v84, s52, v84
    ds_read_b128 v[192:195], v84 offset:0
    ds_read_b128 v[196:199], v84 offset:16384
    ds_read_b128 v[200:203], v84 offset:128
    ds_read_b128 v[204:207], v84 offset:16512
    ds_read_b128 v[208:211], v84 offset:256
    ds_read_b128 v[212:215], v84 offset:16640
    ds_read_b128 v[216:219], v84 offset:384
    ds_read_b128 v[220:223], v84 offset:16768
    s_waitcnt lgkmcnt(0)
    v_perm_b32 v128, v196, v192, s46
    v_perm_b32 v129, v204, v200, s46
    v_perm_b32 v130, v212, v208, s46
    v_perm_b32 v131, v220, v216, s46
    v_perm_b32 v132, v196, v192, s47
    v_perm_b32 v133, v204, v200, s47
    v_perm_b32 v134, v212, v208, s47
    v_perm_b32 v135, v220, v216, s47
    v_perm_b32 v136, v197, v193, s46
    v_perm_b32 v137, v205, v201, s46
    v_perm_b32 v138, v213, v209, s46
    v_perm_b32 v139, v221, v217, s46
    v_perm_b32 v140, v197, v193, s47
    v_perm_b32 v141, v205, v201, s47
    v_perm_b32 v142, v213, v209, s47
    v_perm_b32 v143, v221, v217, s47
    v_perm_b32 v144, v198, v194, s46
    v_perm_b32 v145, v206, v202, s46
    v_perm_b32 v146, v214, v210, s46
    v_perm_b32 v147, v222, v218, s46
    v_perm_b32 v148, v198, v194, s47
    v_perm_b32 v149, v206, v202, s47
    v_perm_b32 v150, v214, v210, s47
    v_perm_b32 v151, v222, v218, s47
    v_perm_b32 v152, v199, v195, s46
    v_perm_b32 v153, v207, v203, s46
    v_perm_b32 v154, v215, v211, s46
    v_perm_b32 v155, v223, v219, s46
    v_perm_b32 v156, v199, v195, s47
    v_perm_b32 v157, v207, v203, s47
    v_perm_b32 v158, v215, v211, s47
    v_perm_b32 v159, v223, v219, s47
    s_lshl_b32 s52, s55, 8
    s_add_u32 s52, s52, 74752
    v_and_b32 v78, 7, v1
    v_lshlrev_b32 v78, 5, v78
    v_and_b32 v87, 8, v1
    v_lshl_add_u32 v78, v87, 1, v78
    v_add_u32 v78, s52, v78
    v_add_u32 v79, 74752, v3
    s_lshl_b32 s52, s4, 12
    s_lshl_b32 s53, s62, 8
    s_add_u32 s52, s52, s53
    s_add_u32 s52, s52, 655360
    v_add_u32 v80, s52, v3
    s_mov_b64 s[8:9], -1
    s_mov_b64 s[10:11], -1
    s_mov_b64 s[12:13], -1
    s_mov_b64 s[14:15], -1
    s_mov_b64 s[16:17], -1
    s_mov_b64 s[18:19], -1
    s_mov_b64 s[20:21], -1
    s_mov_b64 s[22:23], -1
    s_call_b64 s[66:67], L_publish
L_poll1:
    s_sub_u32 s64, s64, 1
    s_cbranch_scc1 L_end
    s_mov_b64 exec, s[8:9]
    s_cbranch_execz L_poll1_0k0
    global_load_dwordx4 v[12:15], v44, s[30:31] sc1
L_poll1_0k0:
    s_mov_b64 exec, s[10:11]
    s_cbranch_execz L_poll1_0k1
    global_load_dwordx4 v[16:19], v45, s[30:31] sc1
L_poll1_0k1:
    s_mov_b64 exec, s[12:13]
    s_cbranch_execz L_poll1_0k2
    global_load_dwordx4 v[20:23], v46, s[30:31] sc1
L_poll1_0k2:
    s_mov_b64 exec, s[14:15]
    s_cbranch_execz L_poll1_0k3
    global_load_dwordx4 v[24:27], v47, s[30:31] sc1
L_poll1_0k3:
    s_mov_b64 exec, s[16:17]
    s_cbranch_execz L_poll1_0k4
    global_load_dwordx4 v[28:31], v48, s[30:31] sc1
L_poll1_0k4:
    s_mov_b64 exec, s[18:19]
    s_cbranch_execz L_poll1_0k5
    global_load_dwordx4 v[32:35], v49, s[30:31] sc1
L_poll1_0k5:
    s_mov_b64 exec, s[20:21]
    s_cbranch_execz L_poll1_0k6
    global_load_dwordx4 v[36:39], v50, s[30:31] sc1
L_poll1_0k6:
    s_mov_b64 exec, s[22:23]
    s_cbranch_execz L_poll1_0k7
    global_load_dwordx4 v[40:43], v51, s[30:31] sc1
L_poll1_0k7:
L_poll1_w:
    s_mov_b64 s[6:7], 0
    s_waitcnt vmcnt(0)
    s_mov_b64 exec, s[8:9]
    s_cbranch_execz L_poll1_1k0
    v_xor_b32 v12, s76, v12
    v_xor_b32 v13, s77, v13
    v_xor_b32 v14, s78, v14
    v_xor_b32 v15, s79, v15
    v_or3_b32 v84, v12, v13, v14
    v_bitop3_b32 v84, v84, v15, v93 bitop3:0x54
    v_cmp_ne_u32 s[8:9], 0, v84
    s_nop 0
    s_or_b64 s[6:7], s[6:7], s[8:9]
L_poll1_1k0:
    s_mov_b64 exec, s[10:11]
    s_cbranch_execz L_poll1_1k1
    v_xor_b32 v16, s76, v16
    v_xor_b32 v17, s77, v17
    v_xor_b32 v18, s78, v18
    v_xor_b32 v19, s79, v19
    v_or3_b32 v84, v16, v17, v18
    v_bitop3_b32 v84, v84, v19, v93 bitop3:0x54
    v_cmp_ne_u32 s[10:11], 0, v84
    s_nop 0
    s_or_b64 s[6:7], s[6:7], s[10:11]
L_poll1_1k1:
    s_mov_b64 exec, s[12:13]
    s_cbranch_execz L_poll1_1k2
    v_xor_b32 v20, s76, v20
    v_xor_b32 v21, s77, v21
    v_xor_b32 v22, s78, v22
    v_xor_b32 v23, s79, v23
    v_or3_b32 v84, v20, v21, v22
    v_bitop3_b32 v84, v84, v23, v93 bitop3:0x54
    v_cmp_ne_u32 s[12:13], 0, v84
    s_nop 0
    s_or_b64 s[6:7], s[6:7], s[12:13]
L_poll1_1k2:
    s_mov_b64 exec, s[14:15]
    s_cbranch_execz L_poll1_1k3
    v_xor_b32 v24, s76, v24
    v_xor_b32 v25, s77, v25
    v_xor_b32 v26, s78, v26
    v_xor_b32 v27, s79, v27
    v_or3_b32 v84, v24, v25, v26
    v_bitop3_b32 v84, v84, v27, v93 bitop3:0x54
    v_cmp_ne_u32 s[14:15], 0, v84
    s_nop 0
    s_or_b64 s[6:7], s[6:7], s[14:15]
L_poll1_1k3:
    s_mov_b64 exec, s[16:17]
    s_cbranch_execz L_poll1_1k4
    v_xor_b32 v28, s76, v28
    v_xor_b32 v29, s77, v29
    v_xor_b32 v30, s78, v30
    v_xor_b32 v31, s79, v31
    v_or3_b32 v84, v28, v29, v30
    v_bitop3_b32 v84, v84, v31, v93 bitop3:0x54
    v_cmp_ne_u32 s[16:17], 0, v84
    s_nop 0
    s_or_b64 s[6:7], s[6:7], s[16:17]
L_poll1_1k4:
    s_mov_b64 exec, s[18:19]
    s_cbranch_execz L_poll1_1k5
    v_xor_b32 v32, s76, v32
    v_xor_b32 v33, s77, v33
    v_xor_b32 v34, s78, v34
    v_xor_b32 v35, s79, v35
    v_or3_b32 v84, v32, v33, v34
    v_bitop3_b32 v84, v84, v35, v93 bitop3:0x54
    v_cmp_ne_u32 s[18:19], 0, v84
    s_nop 0
    s_or_b64 s[6:7], s[6:7], s[18:19]
L_poll1_1k5:
    s_mov_b64 exec, s[20:21]
    s_cbranch_execz L_poll1_1k6
    v_xor_b32 v36, s76, v36
    v_xor_b32 v37, s77, v37
    v_xor_b32 v38, s78, v38
    v_xor_b32 v39, s79, v39
    v_or3_b32 v84, v36, v37, v38
    v_bitop3_b32 v84, v84, v39, v93 bitop3:0x54
    v_cmp_ne_u32 s[20:21], 0, v84
    s_nop 0
    s_or_b64 s[6:7], s[6:7], s[20:21]
L_poll1_1k6:
    s_mov_b64 exec, s[22:23]
    s_cbranch_execz L_poll1_1k7
    v_xor_b32 v40, s76, v40
    v_xor_b32 v41, s77, v41
    v_xor_b32 v42, s78, v42
    v_xor_b32 v43, s79, v43
    v_or3_b32 v84, v40, v41, v42
    v_bitop3_b32 v84, v84, v43, v93 bitop3:0x54
    v_cmp_ne_u32 s[22:23], 0, v84
    s_nop 0
    s_or_b64 s[6:7], s[6:7], s[22:23]
L_poll1_1k7:
    s_cmp_eq_u64 s[6:7], 0
    s_cbranch_scc0 L_poll1
    s_mov_b64 exec, -1
    v_pk_add_f32 v[12:13], v[12:13], v[16:17]
    v_pk_add_f32 v[14:15], v[14:15], v[18:19]
    v_pk_add_f32 v[20:21], v[20:21], v[24:25]
    v_pk_add_f32 v[22:23], v[22:23], v[26:27]
    v_pk_add_f32 v[28:29], v[28:29], v[32:33]
    v_pk_add_f32 v[30:31], v[30:31], v[34:35]
    v_pk_add_f32 v[36:37], v[36:37], v[40:41]
    v_pk_add_f32 v[38:39], v[38:39], v[42:43]
    v_pk_add_f32 v[12:13], v[12:13], v[20:21]
    v_pk_add_f32 v[14:15], v[14:15], v[22:23]
    v_pk_add_f32 v[28:29], v[28:29], v[36:37]
    v_pk_add_f32 v[30:31], v[30:31], v[38:39]
    v_pk_add_f32 v[12:13], v[12:13], v[28:29]
    v_pk_add_f32 v[14:15], v[14:15], v[30:31]
    s_nop 1
    v_permlane32_swap_b32 v12, v14
    v_permlane32_swap_b32 v13, v15
    v_pk_add_f32 v[12:13], v[12:13], v[14:15]
    s_nop 1
    v_permlane16_swap_b32 v12, v13
    v_add_f32 v12, v12, v13
    s_nop 1
    v_mov_b32_dpp v53, v12 row_ror:14 row_mask:0xf bank_mask:0xf
    v_cvt_pk_bf16_f32 v52, v12, v53
    s_nop 1
    v_mov_b32_dpp v53, v52 row_ror:12 row_mask:0xf bank_mask:0xf
    v_mov_b32_dpp v54, v52 row_ror:8 row_mask:0xf bank_mask:0xf
    v_mov_b32_dpp v55, v52 row_ror:4 row_mask:0xf bank_mask:0xf
    s_nop 1
    v_mfma_f32_16x16x32_bf16 v[160:163], v[52:55], v[128:131], 0
    v_mfma_f32_16x16x32_bf16 v[164:167], v[52:55], v[132:135], 0
    v_mfma_f32_16x16x32_bf16 v[168:171], v[52:55], v[136:139], 0
    v_mfma_f32_16x16x32_bf16 v[172:175], v[52:55], v[140:143], 0
    v_mfma_f32_16x16x32_bf16 v[176:179], v[52:55], v[144:147], 0
    v_mfma_f32_16x16x32_bf16 v[180:183], v[52:55], v[148:151], 0
    v_mfma_f32_16x16x32_bf16 v[184:187], v[52:55], v[152:155], 0
    v_mfma_f32_16x16x32_bf16 v[188:191], v[52:55], v[156:159], 0
    s_nop 0
    v_add_f32_dpp v12, v161, v160 row_ror:8 row_mask:0xf bank_mask:0x3
    v_add_f32_dpp v13, v165, v164 row_ror:8 row_mask:0xf bank_mask:0x3
    v_add_f32_dpp v14, v169, v168 row_ror:8 row_mask:0xf bank_mask:0x3
    v_add_f32_dpp v15, v173, v172 row_ror:8 row_mask:0xf bank_mask:0x3
    v_add_f32_dpp v12, v176, v177 row_ror:8 row_mask:0xf bank_mask:0xc
    v_add_f32_dpp v13, v180, v181 row_ror:8 row_mask:0xf bank_mask:0xc
    v_add_f32_dpp v14, v184, v185 row_ror:8 row_mask:0xf bank_mask:0xc
    v_add_f32_dpp v15, v188, v189 row_ror:8 row_mask:0xf bank_mask:0xc
    s_mov_b64 exec, 0xffff
    ds_write_b128 v78, v[12:15]
    s_waitcnt lgkmcnt(0)
    s_barrier
    s_cmp_eq_u32 s3, 4
    s_cbranch_scc0 L_fin
    ds_read_b128 v[12:15], v79 offset:0
    ds_read_b128 v[16:19], v79 offset:256
    ds_read_b128 v[20:23], v79 offset:512
    ds_read_b128 v[24:27], v79 offset:768
    s_waitcnt lgkmcnt(2)
    v_pk_add_f32 v[12:13], v[12:13], v[16:17]
    v_pk_add_f32 v[14:15], v[14:15], v[18:19]
    s_waitcnt lgkmcnt(0)
    v_pk_add_f32 v[20:21], v[20:21], v[24:25]
    v_pk_add_f32 v[22:23], v[22:23], v[26:27]
    v_pk_add_f32 v[12:13], v[12:13], v[20:21]
    v_pk_add_f32 v[14:15], v[14:15], v[22:23]
    v_and_or_b32 v12, v12, v93, s76
    v_and_or_b32 v13, v13, v93, s77
    v_and_or_b32 v14, v14, v93, s78
    v_and_or_b32 v15, v15, v93, s79
    global_store_dwordx4 v80, v[12:15], s[30:31] sc1
    s_branch L_fin
L_st2:
    s_cmp_lt_u32 s3, 4
    s_cbranch_scc0 L_s2a
    v_lshrrev_b32 v5, 4, v1
    v_bfe_u32 v6, v1, 3, 1
    v_lshl_add_u32 v5, v6, 2, v5
    s_lshl_b32 s54, s3, 6
    v_add_u32 v5, s54, v5
    v_mul_u32_u24 v5, 3584, v5
    v_and_b32 v6, 3, v1
    v_lshlrev_b32 v6, 4, v6
    s_lshl_b32 s54, s62, 6
    v_add3_u32 v5, v5, v6, s54
    v_and_b32 v6, 4, v1
    v_cmp_eq_u32 vcc, 0, v6
    v_mov_b32 v6, s22
    v_mov_b32 v4, s20
    v_cndmask_b32 v6, v6, v4, vcc
    v_mov_b32 v7, s23
    v_mov_b32 v4, s21
    v_cndmask_b32 v7, v7, v4, vcc
    v_add_co_u32 v6, vcc, v6, v5
    s_nop 1
    v_addc_co_u32 v7, vcc, 0, v7, vcc
    s_barrier
    s_cmp_lt_u32 s3, 3
    s_cbranch_scc1 L_s2a
    global_load_dwordx4 v[96:99], v[6:7], off nt
    v_add_co_u32 v6, vcc, 28672, v6
    s_nop 1
    v_addc_co_u32 v7, vcc, 0, v7, vcc
    global_load_dwordx4 v[100:103], v[6:7], off nt
    v_add_co_u32 v6, vcc, 28672, v6
    s_nop 1
    v_addc_co_u32 v7, vcc, 0, v7, vcc
    global_load_dwordx4 v[104:107], v[6:7], off nt
    v_add_co_u32 v6, vcc, 28672, v6
    s_nop 1
    v_addc_co_u32 v7, vcc, 0, v7, vcc
    global_load_dwordx4 v[108:111], v[6:7], off nt
    v_add_co_u32 v6, vcc, 28672, v6
    s_nop 1
    v_addc_co_u32 v7, vcc, 0, v7, vcc
    global_load_dwordx4 v[112:115], v[6:7], off nt
    v_add_co_u32 v6, vcc, 28672, v6
    s_nop 1
    v_addc_co_u32 v7, vcc, 0, v7, vcc
    global_load_dwordx4 v[116:119], v[6:7], off nt
    v_add_co_u32 v6, vcc, 28672, v6
    s_nop 1
    v_addc_co_u32 v7, vcc, 0, v7, vcc
    global_load_dwordx4 v[120:123], v[6:7], off nt
    v_add_co_u32 v6, vcc, 28672, v6
    s_nop 1
    v_addc_co_u32 v7, vcc, 0, v7, vcc
    global_load_dwordx4 v[124:127], v[6:7], off nt
L_s2a:
    v_mov_b32 v84, 79088
    ds_read_b32 v84, v84
    v_mov_b32 v93, 0xffffff00
    s_waitcnt lgkmcnt(0)
    v_readfirstlane_b32 s60, v84
    s_nop 0
    s_bfe_u32 s76, s60, 0x80000
    s_bfe_u32 s77, s60, 0x80008
    s_bfe_u32 s78, s60, 0x80010
    s_bfe_u32 s79, s60, 0x80018
    v_and_b32 v86, 15, v1
    s_lshl_b32 s52, s3, 4
    v_add_u32 v86, s52, v86
    v_lshrrev_b32 v89, 4, v1
    v_lshl_add_u32 v87, v86, 2, v89
    v_lshlrev_b32 v87, 1, v87
    global_load_ushort v28, v87, s[8:9]
    s_mul_i32 s52, s3, 8192
    v_add_u32 v84, s52, v3
    ds_read_b128 v[192:195], v84 offset:0
    ds_read_b128 v[196:199], v84 offset:1024
    ds_read_b128 v[200:203], v84 offset:2048
    ds_read_b128 v[204:207], v84 offset:3072
    ds_read_b128 v[208:211], v84 offset:4096
    ds_read_b128 v[212:215], v84 offset:5120
    ds_read_b128 v[216:219], v84 offset:6144
    ds_read_b128 v[220:223], v84 offset:7168
    s_waitcnt lgkmcnt(0)
    v_perm_b32 v128, v196, v192, s46
    v_perm_b32 v129, v204, v200, s46
    v_perm_b32 v130, v212, v208, s46
    v_perm_b32 v131, v220, v216, s46
    v_perm_b32 v132, v196, v192, s47
    v_perm_b32 v133, v204, v200, s47
    v_perm_b32 v134, v212, v208, s47
    v_perm_b32 v135, v220, v216, s47
    v_perm_b32 v136, v197, v193, s46
    v_perm_b32 v137, v205, v201, s46
    v_perm_b32 v138, v213, v209, s46
    v_perm_b32 v139, v221, v217, s46
    v_perm_b32 v140, v197, v193, s47
    v_perm_b32 v141, v205, v201, s47
    v_perm_b32 v142, v213, v209, s47
    v_perm_b32 v143, v221, v217, s47
    v_perm_b32 v144, v198, v194, s46
    v_perm_b32 v145, v206, v202, s46
    v_perm_b32 v146, v214, v210, s46
    v_perm_b32 v147, v222, v218, s46
    v_perm_b32 v148, v198, v194, s47
    v_perm_b32 v149, v206, v202, s47
    v_perm_b32 v150, v214, v210, s47
    v_perm_b32 v151, v222, v218, s47
    v_perm_b32 v152, v199, v195, s46
    v_perm_b32 v153, v207, v203, s46
    v_perm_b32 v154, v215, v211, s46
    v_perm_b32 v155, v223, v219, s46
    v_perm_b32 v156, v199, v195, s47
    v_perm_b32 v157, v207, v203, s47
    v_perm_b32 v158, v215, v211, s47
    v_perm_b32 v159, v223, v219, s47
    v_lshlrev_b32 v87, 11, v89
    v_lshl_add_u32 v36, v86, 4, v87
    v_add_u32 v36, 655360, v36
    v_add_u32 v37, 8192, v36
    v_add_u32 v38, 16384, v36
    v_add_u32 v39, 24576, v36
    s_lshl_b32 s52, s3, 3
    s_add_u32 s52, s52, 78848
    v_mov_b32 v40, s52
    v_bfe_u32 v41, v1, 1, 3
    v_lshlrev_b32 v41, 3, v41
    v_add_u32 v41, 78848, v41
    v_mov_b32 v30, 78848
    s_lshl_b32 s52, s3, 8
    s_add_u32 s52, s52, 74752
    v_and_b32 v42, 7, v1
    v_lshlrev_b32 v42, 5, v42
    v_and_b32 v87, 8, v1
    v_lshl_add_u32 v42, v87, 1, v42
    v_add_u32 v42, s52, v42
    v_add_u32 v43, 74752, v3
    s_lshl_b32 s52, s62, 11
    s_and_b32 s53, s3, 3
    s_lshl_b32 s53, s53, 9
    s_add_u32 s52, s52, s53
    s_add_u32 s52, s52, 720896
    v_and_b32 v80, 15, v1
    v_lshlrev_b32 v80, 4, v80
    v_lshrrev_b32 v87, 5, v1
    v_lshlrev_b32 v87, 8, v87
    v_add3_u32 v80, v80, v87, s52
    s_waitcnt vmcnt(0)
    v_lshlrev_b32 v32, 16, v28
    s_cmp_lt_u32 s3, 3
    s_cbranch_scc1 L_j2
    s_cmp_lt_u32 s3, 4
    s_cbranch_scc1 L_j2b
    v_lshrrev_b32 v8, 4, v1
    v_lshlrev_b32 v8, 10, v8
    v_and_b32 v7, 15, v1
    v_lshl_add_u32 v8, v7, 4, v8
    s_lshl_b32 s54, s62, 15
    s_and_b32 s55, s3, 3
    s_lshl_b32 s55, s55, 8
    s_add_u32 s54, s54, s55
    s_add_u32 s54, s54, 4096
    v_add_u32 v8, s54, v8
    v_add_u32 v9, 8192, v8
    v_add_u32 v10, 16384, v8
    v_add_u32 v11, 24576, v8
    s_mov_b64 exec, 1
    global_load_dword v72, v8, s[24:25] nt
    s_mov_b64 exec, -1
    v_lshrrev_b32 v5, 4, v1
    v_bfe_u32 v6, v1, 3, 1
    v_lshl_add_u32 v5, v6, 2, v5
    s_lshl_b32 s54, s3, 6
    v_add_u32 v5, s54, v5
    v_mul_u32_u24 v5, 3584, v5
    v_and_b32 v6, 3, v1
    v_lshlrev_b32 v6, 4, v6
    s_lshl_b32 s54, s62, 6
    v_add3_u32 v5, v5, v6, s54
    v_and_b32 v6, 4, v1
    v_cmp_eq_u32 vcc, 0, v6
    v_mov_b32 v6, s22
    v_mov_b32 v4, s20
    v_cndmask_b32 v6, v6, v4, vcc
    v_mov_b32 v7, s23
    v_mov_b32 v4, s21
    v_cndmask_b32 v7, v7, v4, vcc
    v_add_co_u32 v6, vcc, v6, v5
    s_nop 1
    v_addc_co_u32 v7, vcc, 0, v7, vcc
    s_call_b64 s[66:67], L_publish
    s_cmp_lt_u32 s3, 3
    s_cbranch_scc1 L_j2a
    global_load_dwordx4 v[96:99], v[6:7], off nt
    v_add_co_u32 v6, vcc, 28672, v6
    s_nop 1
    v_addc_co_u32 v7, vcc, 0, v7, vcc
    global_load_dwordx4 v[100:103], v[6:7], off nt
    v_add_co_u32 v6, vcc, 28672, v6
    s_nop 1
    v_addc_co_u32 v7, vcc, 0, v7, vcc
    global_load_dwordx4 v[104:107], v[6:7], off nt
    v_add_co_u32 v6, vcc, 28672, v6
    s_nop 1
    v_addc_co_u32 v7, vcc, 0, v7, vcc
    global_load_dwordx4 v[108:111], v[6:7], off nt
    v_add_co_u32 v6, vcc, 28672, v6
    s_nop 1
    v_addc_co_u32 v7, vcc, 0, v7, vcc
    global_load_dwordx4 v[112:115], v[6:7], off nt
    v_add_co_u32 v6, vcc, 28672, v6
    s_nop 1
    v_addc_co_u32 v7, vcc, 0, v7, vcc
    global_load_dwordx4 v[116:119], v[6:7], off nt
    v_add_co_u32 v6, vcc, 28672, v6
    s_nop 1
    v_addc_co_u32 v7, vcc, 0, v7, vcc
    global_load_dwordx4 v[120:123], v[6:7], off nt
    v_add_co_u32 v6, vcc, 28672, v6
    s_nop 1
    v_addc_co_u32 v7, vcc, 0, v7, vcc
    global_load_dwordx4 v[124:127], v[6:7], off nt
    global_load_dwordx4 v[192:195], v8, s[24:25] offset:-4096 nt
    global_load_dwordx4 v[196:199], v8, s[24:25] offset:0 nt
    global_load_dwordx4 v[200:203], v9, s[24:25] offset:-4096 nt
    global_load_dwordx4 v[204:207], v9, s[24:25] offset:0 nt
    global_load_dwordx4 v[208:211], v10, s[24:25] offset:-4096 nt
    global_load_dwordx4 v[212:215], v10, s[24:25] offset:0 nt
    global_load_dwordx4 v[216:219], v11, s[24:25] offset:-4096 nt
    global_load_dwordx4 v[220:223], v11, s[24:25] offset:0 nt
    s_waitcnt vmcnt(8)
L_j2b:
    v_perm_b32 v128, v100, v96, s46
    v_perm_b32 v129, v108, v104, s46
    v_perm_b32 v130, v116, v112, s46
    v_perm_b32 v131, v124, v120, s46
    v_perm_b32 v132, v100, v96, s47
    v_perm_b32 v133, v108, v104, s47
    v_perm_b32 v134, v116, v112, s47
    v_perm_b32 v135, v124, v120, s47
    v_perm_b32 v136, v101, v97, s46
    v_perm_b32 v137, v109, v105, s46
    v_perm_b32 v138, v117, v113, s46
    v_perm_b32 v139, v125, v121, s46
    v_perm_b32 v140, v101, v97, s47
    v_perm_b32 v141, v109, v105, s47
    v_perm_b32 v142, v117, v113, s47
    v_perm_b32 v143, v125, v121, s47
    v_perm_b32 v144, v102, v98, s46
    v_perm_b32 v145, v110, v106, s46
    v_perm_b32 v146, v118, v114, s46
    v_perm_b32 v147, v126, v122, s46
    v_perm_b32 v148, v102, v98, s47
    v_perm_b32 v149, v110, v106, s47
    v_perm_b32 v150, v118, v114, s47
    v_perm_b32 v151, v126, v122, s47
    v_perm_b32 v152, v103, v99, s46
    v_perm_b32 v153, v111, v107, s46
    v_perm_b32 v154, v119, v115, s46
    v_perm_b32 v155, v127, v123, s46
    v_perm_b32 v156, v103, v99, s47
    v_perm_b32 v157, v111, v107, s47
    v_perm_b32 v158, v119, v115, s47
    v_perm_b32 v159, v127, v123, s47
    s_branch L_j2
L_j2a:
    global_load_dwordx4 v[192:195], v8, s[24:25] offset:-4096 nt
    global_load_dwordx4 v[196:199], v8, s[24:25] offset:0 nt
    global_load_dwordx4 v[200:203], v9, s[24:25] offset:-4096 nt
    global_load_dwordx4 v[204:207], v9, s[24:25] offset:0 nt
    global_load_dwordx4 v[208:211], v10, s[24:25] offset:-4096 nt
    global_load_dwordx4 v[212:215], v10, s[24:25] offset:0 nt
    global_load_dwordx4 v[216:219], v11, s[24:25] offset:-4096 nt
    global_load_dwordx4 v[220:223], v11, s[24:25] offset:0 nt
L_j2:
    v_mov_b32 v52, 0x3f803f80
    v_mov_b32 v53, 0x3f803f80
    v_mov_b32 v54, 0x3f803f80
    v_mov_b32 v55, 0x3f803f80
    s_nop 1
    v_mfma_f32_16x16x32_bf16 v[160:163], v[52:55], v[128:131], 0
    v_mfma_f32_16x16x32_bf16 v[164:167], v[52:55], v[132:135], 0
    v_mfma_f32_16x16x32_bf16 v[168:171], v[52:55], v[136:139], 0
    v_mfma_f32_16x16x32_bf16 v[172:175], v[52:55], v[140:143], 0
    v_mfma_f32_16x16x32_bf16 v[176:179], v[52:55], v[144:147], 0
    v_mfma_f32_16x16x32_bf16 v[180:183], v[52:55], v[148:151], 0
    v_mfma_f32_16x16x32_bf16 v[184:187], v[52:55], v[152:155], 0
    v_mfma_f32_16x16x32_bf16 v[188:191], v[52:55], v[156:159], 0
    s_nop 0
    v_add_f32_dpp v12, v161, v160 row_ror:8 row_mask:0xf bank_mask:0x3
    v_add_f32_dpp v13, v165, v164 row_ror:8 row_mask:0xf bank_mask:0x3
    v_add_f32_dpp v14, v169, v168 row_ror:8 row_mask:0xf bank_mask:0x3
    v_add_f32_dpp v15, v173, v172 row_ror:8 row_mask:0xf bank_mask:0x3
    v_add_f32_dpp v12, v176, v177 row_ror:8 row_mask:0xf bank_mask:0xc
    v_add_f32_dpp v13, v180, v181 row_ror:8 row_mask:0xf bank_mask:0xc
    v_add_f32_dpp v14, v184, v185 row_ror:8 row_mask:0xf bank_mask:0xc
    v_add_f32_dpp v15, v188, v189 row_ror:8 row_mask:0xf bank_mask:0xc
    s_mov_b64 exec, 0xffff
    ds_write_b128 v42, v[12:15] offset:2048
    s_mov_b64 exec, -1
    s_waitcnt lgkmcnt(0)
    s_barrier
    s_cmp_lt_u32 s3, 4
    s_cbranch_scc1 L_poll2
    ds_read_b128 v[64:67], v43 offset:2048
    ds_read_b128 v[68:71], v43 offset:3072
    s_waitcnt lgkmcnt(0)
    v_pk_add_f32 v[64:65], v[64:65], v[68:69]
    v_pk_add_f32 v[66:67], v[66:67], v[70:71]
    s_nop 1
    v_permlane32_swap_b32 v64, v66
    v_permlane32_swap_b32 v65, v67
    v_pk_add_f32 v[64:65], v[64:65], v[66:67]
    s_nop 1
    v_permlane16_swap_b32 v64, v65
    v_add_f32 v64, v64, v65
    s_waitcnt vmcnt(0)
    v_perm_b32 v224, v196, v192, s46
    v_perm_b32 v225, v204, v200, s46
    v_perm_b32 v226, v212, v208, s46
    v_perm_b32 v227, v220, v216, s46
    v_perm_b32 v228, v196, v192, s47
    v_perm_b32 v229, v204, v200, s47
    v_perm_b32 v230, v212, v208, s47
    v_perm_b32 v231, v220, v216, s47
    v_perm_b32 v232, v197, v193, s46
    v_perm_b32 v233, v205, v201, s46
    v_perm_b32 v234, v213, v209, s46
    v_perm_b32 v235, v221, v217, s46
    v_perm_b32 v236, v197, v193, s47
    v_perm_b32 v237, v205, v201, s47
    v_perm_b32 v238, v213, v209, s47
    v_perm_b32 v239, v221, v217, s47
    v_perm_b32 v240, v198, v194, s46
    v_perm_b32 v241, v206, v202, s46
    v_perm_b32 v242, v214, v210, s46
    v_perm_b32 v243, v222, v218, s46
    v_perm_b32 v244, v198, v194, s47
    v_perm_b32 v245, v206, v202, s47
    v_perm_b32 v246, v214, v210, s47
    v_perm_b32 v247, v222, v218, s47
    v_perm_b32 v248, v199, v195, s46
    v_perm_b32 v249, v207, v203, s46
    v_perm_b32 v250, v215, v211, s46
    v_perm_b32 v251, v223, v219, s46
    v_perm_b32 v252, v199, v195, s47
    v_perm_b32 v253, v207, v203, s47
    v_perm_b32 v254, v215, v211, s47
    v_perm_b32 v255, v223, v219, s47
L_poll2:
L_poll2_l:
    s_sub_u32 s64, s64, 1
    s_cbranch_scc1 L_end
    global_load_dwordx4 v[96:99], v36, s[30:31] sc1
    global_load_dwordx4 v[100:103], v37, s[30:31] sc1
    global_load_dwordx4 v[104:107], v38, s[30:31] sc1
    global_load_dwordx4 v[108:111], v39, s[30:31] sc1
    s_waitcnt vmcnt(3)
    v_xor_b32 v12, s76, v96
    v_xor_b32 v13, s77, v97
    v_xor_b32 v14, s78, v98
    v_xor_b32 v15, s79, v99
    v_or_b32 v84, v12, v13
    v_or_b32 v85, v14, v15
    s_waitcnt vmcnt(2)
    v_xor_b32 v100, s76, v100
    v_xor_b32 v101, s77, v101
    v_xor_b32 v102, s78, v102
    v_xor_b32 v103, s79, v103
    v_or3_b32 v84, v84, v100, v101
    v_or3_b32 v85, v85, v102, v103
    v_pk_add_f32 v[12:13], v[12:13], v[100:101]
    v_pk_add_f32 v[14:15], v[14:15], v[102:103]
    s_waitcnt vmcnt(1)
    v_xor_b32 v104, s76, v104
    v_xor_b32 v105, s77, v105
    v_xor_b32 v106, s78, v106
    v_xor_b32 v107, s79, v107
    v_or3_b32 v84, v84, v104, v105
    v_or3_b32 v85, v85, v106, v107
    v_pk_add_f32 v[12:13], v[12:13], v[104:105]
    v_pk_add_f32 v[14:15], v[14:15], v[106:107]
    s_waitcnt vmcnt(0)
    v_xor_b32 v108, s76, v108
    v_xor_b32 v109, s77, v109
    v_xor_b32 v110, s78, v110
    v_xor_b32 v111, s79, v111
    v_or3_b32 v84, v84, v108, v109
    v_or3_b32 v85, v85, v110, v111
    v_bitop3_b32 v84, v84, v85, v93 bitop3:0x54
    v_cmp_ne_u32 vcc, 0, v84
    v_pk_add_f32 v[12:13], v[12:13], v[108:109]
    v_pk_add_f32 v[14:15], v[14:15], v[110:111]
    s_cbranch_vccz L_poll2_got
    s_branch L_poll2_l
L_poll2_got:
    s_nop 0
    v_permlane32_swap_b32 v12, v14
    v_permlane32_swap_b32 v13, v15
    v_pk_add_f32 v[12:13], v[12:13], v[14:15]
    s_nop 1
    v_permlane16_swap_b32 v12, v13
    v_add_f32 v12, v12, v13
    v_cvt_pk_bf16_f32 v12, v12, v12
    v_lshlrev_b32 v12, 16, v12
    v_add_f32 v12, v32, v12
    s_nop 1
    v_mov_b32_dpp v53, v12 row_ror:14 row_mask:0xf bank_mask:0xf
    v_cvt_pk_bf16_f32 v52, v12, v53
    v_lshlrev_b32 v20, 16, v52
    s_nop 0
    v_mov_b32_dpp v53, v52 row_ror:12 row_mask:0xf bank_mask:0xf
    v_mov_b32_dpp v54, v52 row_ror:8 row_mask:0xf bank_mask:0xf
    v_mov_b32_dpp v55, v52 row_ror:4 row_mask:0xf bank_mask:0xf
    v_readfirstlane_b32 s54, v20
    s_nop 0
    v_mfma_f32_16x16x32_bf16 v[160:163], v[52:55], v[128:131], 0
    v_subrev_f32 v20, s54, v20
    v_mul_f32 v21, v20, v20
    v_mfma_f32_16x16x32_bf16 v[164:167], v[52:55], v[132:135], 0
    s_nop 0
    v_permlane32_swap_b32 v20, v21
    v_add_f32 v20, v20, v21
    v_mov_b32 v21, v20
    v_mfma_f32_16x16x32_bf16 v[168:171], v[52:55], v[136:139], 0
    s_nop 0
    v_permlane16_swap_b32 v21, v20
    v_add_f32 v20, v20, v21
    v_mfma_f32_16x16x32_bf16 v[172:175], v[52:55], v[140:143], 0
    s_nop 0
    v_add_f32_dpp v20, v20, v20 row_ror:8 row_mask:0xf bank_mask:0xf
    v_mfma_f32_16x16x32_bf16 v[176:179], v[52:55], v[144:147], 0
    s_nop 0
    v_add_f32_dpp v20, v20, v20 row_ror:4 row_mask:0xf bank_mask:0xf
    v_mfma_f32_16x16x32_bf16 v[180:183], v[52:55], v[148:151], 0
    s_nop 0
    v_add_f32_dpp v20, v20, v20 row_ror:2 row_mask:0xf bank_mask:0xf
    v_mfma_f32_16x16x32_bf16 v[184:187], v[52:55], v[152:155], 0
    s_nop 0
    v_add_f32_dpp v20, v20, v20 row_ror:1 row_mask:0xf bank_mask:0xf
    v_mfma_f32_16x16x32_bf16 v[188:191], v[52:55], v[156:159], 0
    v_readlane_b32 s55, v20, 32
    v_mul_f32 v21, 0x3c800000, v20
    v_add_f32 v22, s54, v21
    v_fma_f32 v23, -v21, v20, s55
    v_add_f32_dpp v12, v161, v160 row_ror:8 row_mask:0xf bank_mask:0x3
    v_add_f32_dpp v13, v165, v164 row_ror:8 row_mask:0xf bank_mask:0x3
    v_add_f32_dpp v14, v169, v168 row_ror:8 row_mask:0xf bank_mask:0x3
    v_add_f32_dpp v15, v173, v172 row_ror:8 row_mask:0xf bank_mask:0x3
    v_add_f32_dpp v12, v176, v177 row_ror:8 row_mask:0xf bank_mask:0xc
    v_add_f32_dpp v13, v180, v181 row_ror:8 row_mask:0xf bank_mask:0xc
    v_add_f32_dpp v14, v184, v185 row_ror:8 row_mask:0xf bank_mask:0xc
    v_add_f32_dpp v15, v188, v189 row_ror:8 row_mask:0xf bank_mask:0xc
    s_mov_b64 exec, 0xffff
    ds_write_b64 v40, v[22:23]
    ds_write_b128 v42, v[12:15]
    s_mov_b64 exec, -1
    s_waitcnt lgkmcnt(0)
    s_barrier
    s_cmp_lt_u32 s3, 4
    s_cbranch_scc1 L_fin
    ds_read_b64 v[20:21], v41
    ds_read_b32 v22, v30
    ds_read_b128 v[12:15], v43
    ds_read_b128 v[16:19], v43 offset:1024
    s_waitcnt lgkmcnt(2)
    v_sub_f32 v20, v20, v22
    v_mul_f32 v23, 0x42800000, v20
    v_fmac_f32 v21, v23, v20
    v_add_f32_dpp v20, v20, v20 row_ror:8 row_mask:0xf bank_mask:0xf
    s_waitcnt lgkmcnt(0)
    v_add_f32_dpp v21, v21, v21 row_ror:8 row_mask:0xf bank_mask:0xf
    v_pk_add_f32 v[12:13], v[12:13], v[16:17]
    v_add_f32_dpp v20, v20, v20 row_ror:4 row_mask:0xf bank_mask:0xf
    v_pk_add_f32 v[14:15], v[14:15], v[18:19]
    v_add_f32_dpp v21, v21, v21 row_ror:4 row_mask:0xf bank_mask:0xf
    v_add_f32_dpp v20, v20, v20 row_ror:2 row_mask:0xf bank_mask:0xf
    v_permlane32_swap_b32 v12, v14
    v_add_f32_dpp v21, v21, v21 row_ror:2 row_mask:0xf bank_mask:0xf
    v_permlane32_swap_b32 v13, v15
    v_mul_f32 v23, 0x41000000, v20
    v_fma_f32 v21, -v23, v20, v21
    v_fmac_f32 v22, 0x3e000000, v20
    v_mul_f32 v21, 0x3b000000, v21
    v_cvt_pk_bf16_f32 v23, v22, v21
    v_and_b32 v21, 0xffff0000, v23
    v_add_f32 v21, 0x3727c5ac, v21
    v_cvt_pk_bf16_f32 v24, v21, v21
    v_lshlrev_b32 v21, 16, v24
    v_sqrt_f32 v21, v21
    v_pk_add_f32 v[12:13], v[12:13], v[14:15]
    v_cvt_pk_bf16_f32 v24, v21, v21
    v_lshlrev_b32 v21, 16, v24
    v_rcp_f32 v21, v21
    v_permlane16_swap_b32 v12, v13
    v_lshlrev_b32 v22, 16, v23
    v_add_f32 v12, v12, v13
    v_fma_f32 v12, -v22, v64, v12
    v_mul_f32 v12, v21, v12
    v_cvt_pk_bf16_f32 v12, v12, v12
    v_lshlrev_b32 v12, 16, v12
    s_nop 1
    v_mul_f32_dpp v12, v12, v12 row_ror:8 row_mask:0xf bank_mask:0xf
    s_nop 1
    v_mov_b32_dpp v53, v12 row_ror:15 row_mask:0xf bank_mask:0xf
    v_cvt_pk_bf16_f32 v52, v12, v53
    s_nop 1
    v_mov_b32_dpp v53, v52 row_ror:14 row_mask:0xf bank_mask:0xf
    v_mov_b32_dpp v54, v52 row_ror:12 row_mask:0xf bank_mask:0xf
    v_mov_b32_dpp v55, v52 row_ror:10 row_mask:0xf bank_mask:0xf
    s_nop 1
    v_mfma_f32_16x16x32_bf16 v[160:163], v[52:55], v[224:227], 0
    v_mfma_f32_16x16x32_bf16 v[164:167], v[52:55], v[228:231], 0
    v_mfma_f32_16x16x32_bf16 v[168:171], v[52:55], v[232:235], 0
    v_mfma_f32_16x16x32_bf16 v[172:175], v[52:55], v[236:239], 0
    v_mfma_f32_16x16x32_bf16 v[176:179], v[52:55], v[240:243], 0
    v_mfma_f32_16x16x32_bf16 v[180:183], v[52:55], v[244:247], 0
    v_mfma_f32_16x16x32_bf16 v[184:187], v[52:55], v[248:251], 0
    v_mfma_f32_16x16x32_bf16 v[188:191], v[52:55], v[252:255], 0
    s_nop 0
    v_and_or_b32 v12, v160, v93, s76
    v_and_or_b32 v13, v164, v93, s77
    v_and_or_b32 v14, v168, v93, s78
    v_and_or_b32 v15, v172, v93, s79
    s_mov_b32 exec_lo, 0
    s_mov_b32 exec_hi, 0xffff
    v_and_or_b32 v12, v176, v93, s76
    v_and_or_b32 v13, v180, v93, s77
    v_and_or_b32 v14, v184, v93, s78
    v_and_or_b32 v15, v188, v93, s79
    s_mov_b32 exec_lo, 0xffff
    global_store_dwordx4 v80, v[12:15], s[30:31] sc1
    s_mov_b64 exec, -1
    s_branch L_fin
L_st3:
    v_mov_b32 v84, 79088
    ds_read_b32 v84, v84
    v_mov_b32 v93, 0xffffff00
    s_waitcnt lgkmcnt(0)
    v_readfirstlane_b32 s60, v84
    s_nop 0
    s_bfe_u32 s76, s60, 0x80000
    s_bfe_u32 s77, s60, 0x80008
    s_bfe_u32 s78, s60, 0x80010
    s_bfe_u32 s79, s60, 0x80018
    s_lshr_b32 s53, s62, 2
    s_lshl_b32 s53, s53, 7
    s_and_b32 s52, s62, 1
    s_lshl_b32 s52, s52, 6
    s_add_u32 s53, s53, s52
    s_and_b32 s52, s62, 2
    s_lshl_b32 s52, s52, 1
    s_add_u32 s53, s53, s52
    v_and_b32 v86, 7, v1
    v_lshlrev_b32 v45, 3, v86
    v_add_u32 v45, s53, v45
    v_lshrrev_b32 v89, 4, v1
    v_add_lshl_u32 v80, v45, v89, 1
    global_load_ushort v60, v80, s[8:9]
    s_mov_b64 exec, 1
    global_load_ushort v72, v80, s[26:27] nt
    s_mov_b64 exec, -1
    v_lshrrev_b32 v87, 3, v1
    v_lshlrev_b32 v87, 11, v87
    v_lshl_add_u32 v44, v45, 2, v87
    v_add_u32 v44, 655360, v44
    v_lshl_add_u32 v87, v86, 4, v87
    s_lshl_b32 s52, s62, 7
    v_add_u32 v87, s52, v87
    v_add_u32 v46, 720896, v87
    v_add_u32 v47, 737280, v87
    v_add_u32 v48, 753664, v87
    v_add_u32 v49, 770048, v87
    v_add_u32 v50, 786432, v87
    v_add_u32 v51, 802816, v87
    v_add_u32 v52, 819200, v87
    s_barrier
    s_barrier
    v_mov_b32 v61, s60
    v_mov_b32 v62, 0
    v_add_u32 v45, 16384, v44
    global_load_dwordx4 v[96:99], v46, s[30:31] sc1
    global_load_dwordx4 v[100:103], v47, s[30:31] sc1
    global_load_dwordx4 v[104:107], v48, s[30:31] sc1
    global_load_dwordx4 v[108:111], v49, s[30:31] sc1
    global_load_dwordx4 v[112:115], v50, s[30:31] sc1
    global_load_dwordx4 v[116:119], v51, s[30:31] sc1
    global_load_dwordx4 v[120:123], v52, s[30:31] sc1
L_poll3a:
    s_sub_u32 s64, s64, 1
    s_cbranch_scc1 L_end
    global_load_dwordx4 v[12:15], v44, s[30:31] sc1
    global_load_dwordx4 v[16:19], v45, s[30:31] sc1
    s_waitcnt vmcnt(1)
    v_xor_b32 v12, s76, v12
    v_xor_b32 v13, s77, v13
    v_xor_b32 v14, s78, v14
    v_xor_b32 v15, s79, v15
    v_or_b32 v84, v12, v13
    v_or_b32 v85, v14, v15
    s_waitcnt vmcnt(0)
    v_xor_b32 v16, s76, v16
    v_xor_b32 v17, s77, v17
    v_xor_b32 v18, s78, v18
    v_xor_b32 v19, s79, v19
    v_or3_b32 v84, v84, v16, v17
    v_or3_b32 v85, v85, v18, v19
    v_bitop3_b32 v84, v84, v85, v93 bitop3:0x54
    v_cmp_ne_u32 vcc, 0, v84
    s_cbranch_vccnz L_poll3a
    v_pk_add_f32 v[12:13], v[12:13], v[16:17]
    v_pk_add_f32 v[14:15], v[14:15], v[18:19]
    s_nop 1
    v_permlane32_swap_b32 v12, v14
    v_permlane32_swap_b32 v13, v15
    v_add_f32 v12, v12, v14
    v_add_f32 v13, v13, v15
    s_nop 1
    v_permlane16_swap_b32 v12, v13
    v_add_f32 v12, v12, v13
    s_nop 1
    v_add_f32_dpp v12, v12, v12 row_ror:8 row_mask:0xf bank_mask:0xf
    v_cvt_pk_bf16_f32 v12, v12, v12
    v_lshlrev_b32 v12, 16, v12
    v_lshlrev_b32 v60, 16, v60
    v_add_f32 v60, v60, v12
    v_cvt_pk_bf16_f32 v60, v60, v60
    v_lshlrev_b32 v60, 16, v60
    s_cmp_eq_u32 s62, 0
    s_cbranch_scc0 L_noep
    s_mov_b64 exec, 1
    global_store_dword v62, v61, s[30:31]
    s_mov_b64 exec, -1
L_noep:
L_poll3b:
    global_load_dwordx4 v[96:99], v46, s[30:31] sc1
    global_load_dwordx4 v[100:103], v47, s[30:31] sc1
    global_load_dwordx4 v[104:107], v48, s[30:31] sc1
    global_load_dwordx4 v[108:111], v49, s[30:31] sc1
    global_load_dwordx4 v[112:115], v50, s[30:31] sc1
    global_load_dwordx4 v[116:119], v51, s[30:31] sc1
    global_load_dwordx4 v[120:123], v52, s[30:31] sc1
L_poll3b_l:
    s_sub_u32 s64, s64, 1
    s_cbranch_scc1 L_end
    global_load_dwordx4 v[128:131], v46, s[30:31] sc1
    global_load_dwordx4 v[132:135], v47, s[30:31] sc1
    global_load_dwordx4 v[136:139], v48, s[30:31] sc1
    global_load_dwordx4 v[140:143], v49, s[30:31] sc1
    global_load_dwordx4 v[144:147], v50, s[30:31] sc1
    global_load_dwordx4 v[148:151], v51, s[30:31] sc1
    global_load_dwordx4 v[152:155], v52, s[30:31] sc1
    s_waitcnt vmcnt(13)
    v_xor_b32 v12, s76, v96
    v_xor_b32 v13, s77, v97
    v_xor_b32 v14, s78, v98
    v_xor_b32 v15, s79, v99
    v_or_b32 v84, v12, v13
    v_or_b32 v85, v14, v15
    s_waitcnt vmcnt(12)
    v_xor_b32 v100, s76, v100
    v_xor_b32 v101, s77, v101
    v_xor_b32 v102, s78, v102
    v_xor_b32 v103, s79, v103
    v_or3_b32 v84, v84, v100, v101
    v_or3_b32 v85, v85, v102, v103
    v_pk_add_f32 v[12:13], v[12:13], v[100:101]
    v_pk_add_f32 v[14:15], v[14:15], v[102:103]
    s_waitcnt vmcnt(11)
    v_xor_b32 v104, s76, v104
    v_xor_b32 v105, s77, v105
    v_xor_b32 v106, s78, v106
    v_xor_b32 v107, s79, v107
    v_or3_b32 v84, v84, v104, v105
    v_or3_b32 v85, v85, v106, v107
    v_pk_add_f32 v[12:13], v[12:13], v[104:105]
    v_pk_add_f32 v[14:15], v[14:15], v[106:107]
    s_waitcnt vmcnt(10)
    v_xor_b32 v108, s76, v108
    v_xor_b32 v109, s77, v109
    v_xor_b32 v110, s78, v110
    v_xor_b32 v111, s79, v111
    v_or3_b32 v84, v84, v108, v109
    v_or3_b32 v85, v85, v110, v111
    v_pk_add_f32 v[12:13], v[12:13], v[108:109]
    v_pk_add_f32 v[14:15], v[14:15], v[110:111]
    s_waitcnt vmcnt(9)
    v_xor_b32 v112, s76, v112
    v_xor_b32 v113, s77, v113
    v_xor_b32 v114, s78, v114
    v_xor_b32 v115, s79, v115
    v_or3_b32 v84, v84, v112, v113
    v_or3_b32 v85, v85, v114, v115
    v_pk_add_f32 v[12:13], v[12:13], v[112:113]
    v_pk_add_f32 v[14:15], v[14:15], v[114:115]
    s_waitcnt vmcnt(8)
    v_xor_b32 v116, s76, v116
    v_xor_b32 v117, s77, v117
    v_xor_b32 v118, s78, v118
    v_xor_b32 v119, s79, v119
    v_or3_b32 v84, v84, v116, v117
    v_or3_b32 v85, v85, v118, v119
    v_pk_add_f32 v[12:13], v[12:13], v[116:117]
    v_pk_add_f32 v[14:15], v[14:15], v[118:119]
    s_waitcnt vmcnt(7)
    v_xor_b32 v120, s76, v120
    v_xor_b32 v121, s77, v121
    v_xor_b32 v122, s78, v122
    v_xor_b32 v123, s79, v123
    v_or3_b32 v84, v84, v120, v121
    v_or3_b32 v85, v85, v122, v123
    v_bitop3_b32 v84, v84, v85, v93 bitop3:0x54
    v_cmp_ne_u32 vcc, 0, v84
    v_pk_add_f32 v[12:13], v[12:13], v[120:121]
    v_pk_add_f32 v[14:15], v[14:15], v[122:123]
    s_cbranch_vccz L_poll3b_got
    global_load_dwordx4 v[96:99], v46, s[30:31] sc1
    global_load_dwordx4 v[100:103], v47, s[30:31] sc1
    global_load_dwordx4 v[104:107], v48, s[30:31] sc1
    global_load_dwordx4 v[108:111], v49, s[30:31] sc1
    global_load_dwordx4 v[112:115], v50, s[30:31] sc1
    global_load_dwordx4 v[116:119], v51, s[30:31] sc1
    global_load_dwordx4 v[120:123], v52, s[30:31] sc1
    s_waitcnt vmcnt(13)
    v_xor_b32 v12, s76, v128
    v_xor_b32 v13, s77, v129
    v_xor_b32 v14, s78, v130
    v_xor_b32 v15, s79, v131
    v_or_b32 v84, v12, v13
    v_or_b32 v85, v14, v15
    s_waitcnt vmcnt(12)
    v_xor_b32 v132, s76, v132
    v_xor_b32 v133, s77, v133
    v_xor_b32 v134, s78, v134
    v_xor_b32 v135, s79, v135
    v_or3_b32 v84, v84, v132, v133
    v_or3_b32 v85, v85, v134, v135
    v_pk_add_f32 v[12:13], v[12:13], v[132:133]
    v_pk_add_f32 v[14:15], v[14:15], v[134:135]
    s_waitcnt vmcnt(11)
    v_xor_b32 v136, s76, v136
    v_xor_b32 v137, s77, v137
    v_xor_b32 v138, s78, v138
    v_xor_b32 v139, s79, v139
    v_or3_b32 v84, v84, v136, v137
    v_or3_b32 v85, v85, v138, v139
    v_pk_add_f32 v[12:13], v[12:13], v[136:137]
    v_pk_add_f32 v[14:15], v[14:15], v[138:139]
    s_waitcnt vmcnt(10)
    v_xor_b32 v140, s76, v140
    v_xor_b32 v141, s77, v141
    v_xor_b32 v142, s78, v142
    v_xor_b32 v143, s79, v143
    v_or3_b32 v84, v84, v140, v141
    v_or3_b32 v85, v85, v142, v143
    v_pk_add_f32 v[12:13], v[12:13], v[140:141]
    v_pk_add_f32 v[14:15], v[14:15], v[142:143]
    s_waitcnt vmcnt(9)
    v_xor_b32 v144, s76, v144
    v_xor_b32 v145, s77, v145
    v_xor_b32 v146, s78, v146
    v_xor_b32 v147, s79, v147
    v_or3_b32 v84, v84, v144, v145
    v_or3_b32 v85, v85, v146, v147
    v_pk_add_f32 v[12:13], v[12:13], v[144:145]
    v_pk_add_f32 v[14:15], v[14:15], v[146:147]
    s_waitcnt vmcnt(8)
    v_xor_b32 v148, s76, v148
    v_xor_b32 v149, s77, v149
    v_xor_b32 v150, s78, v150
    v_xor_b32 v151, s79, v151
    v_or3_b32 v84, v84, v148, v149
    v_or3_b32 v85, v85, v150, v151
    v_pk_add_f32 v[12:13], v[12:13], v[148:149]
    v_pk_add_f32 v[14:15], v[14:15], v[150:151]
    s_waitcnt vmcnt(7)
    v_xor_b32 v152, s76, v152
    v_xor_b32 v153, s77, v153
    v_xor_b32 v154, s78, v154
    v_xor_b32 v155, s79, v155
    v_or3_b32 v84, v84, v152, v153
    v_or3_b32 v85, v85, v154, v155
    v_bitop3_b32 v84, v84, v85, v93 bitop3:0x54
    v_cmp_ne_u32 vcc, 0, v84
    v_pk_add_f32 v[12:13], v[12:13], v[152:153]
    v_pk_add_f32 v[14:15], v[14:15], v[154:155]
    s_cbranch_vccz L_poll3b_got
    s_branch L_poll3b_l
L_poll3b_got:
    s_nop 0
    v_permlane32_swap_b32 v12, v14
    v_permlane32_swap_b32 v13, v15
    v_add_f32 v12, v12, v14
    v_add_f32 v13, v13, v15
    s_nop 1
    v_permlane16_swap_b32 v12, v13
    v_add_f32 v12, v12, v13
    s_nop 1
    v_add_f32_dpp v12, v12, v12 row_ror:8 row_mask:0xf bank_mask:0xf
    v_cvt_pk_bf16_f32 v12, v12, v12
    v_lshlrev_b32 v12, 16, v12
    v_add_f32 v12, v60, v12
    v_cvt_pk_bf16_f32 v12, v12, v12
    s_mov_b32 exec_lo, 0x00ff00ff
    s_mov_b32 exec_hi, 0x00ff00ff
    global_store_short v80, v12, s[26:27]
    s_mov_b64 exec, -1
L_fin:
L_end:
    s_endpgm
L_publish:
    v_and_b32 v84, 3, v1
    v_lshlrev_b32 v84, 3, v84
    v_add_u32 v84, 78912, v84
    ds_read_b32 v56, v84 offset:0
    ds_read_b32 v58, v84 offset:32
    ds_read_b32 v60, v84 offset:64
    ds_read_b32 v62, v84 offset:96
    ds_read_b64 v[64:65], v84 offset:128
    v_mov_b32 v85, 79112
    ds_read_b32 v85, v85
    s_and_b32 s52, s3, 1
    s_lshl_b32 s52, s52, 10
    s_lshl_b32 s53, s49, 11
    s_add_u32 s53, s53, 65536
    s_add_u32 s53, s53, s52
    s_add_u32 s52, s52, 66560
    s_waitcnt lgkmcnt(0)
    v_readfirstlane_b32 s54, v85
    v_sub_f32 v56, v56, v64
    v_sub_f32 v58, v58, v64
    v_sub_f32 v60, v60, v64
    v_sub_f32 v62, v62, v64
    v_exp_f32 v56, v56
    v_exp_f32 v58, v58
    v_exp_f32 v60, v60
    v_exp_f32 v62, v62
    v_mul_f32 v56, v56, v65
    v_mul_f32 v58, v58, v65
    v_mul_f32 v60, v60, v65
    v_mul_f32 v62, v62, v65
    v_mov_b32 v57, v56
    v_mov_b32 v59, v58
    v_mov_b32 v61, v60
    v_mov_b32 v63, v62
    v_add_u32 v84, s52, v3
    v_add_u32 v85, s53, v3
    s_barrier
    s_cmp_gt_u32 s3, 5
    s_cbranch_scc1 L_pubret
    ds_read_b128 v[12:15], v84 offset:0
    ds_read_b128 v[16:19], v84 offset:2048
    ds_read_b128 v[20:23], v84 offset:4096
    ds_read_b128 v[24:27], v84 offset:6144
    s_waitcnt lgkmcnt(3)
    v_pk_mul_f32 v[12:13], v[12:13], v[56:57]
    v_pk_mul_f32 v[14:15], v[14:15], v[56:57]
    s_waitcnt lgkmcnt(2)
    v_pk_fma_f32 v[12:13], v[16:17], v[58:59], v[12:13]
    v_pk_fma_f32 v[14:15], v[18:19], v[58:59], v[14:15]
    s_waitcnt lgkmcnt(1)
    v_pk_fma_f32 v[12:13], v[20:21], v[60:61], v[12:13]
    v_pk_fma_f32 v[14:15], v[22:23], v[60:61], v[14:15]
    s_waitcnt lgkmcnt(0)
    v_pk_fma_f32 v[12:13], v[24:25], v[62:63], v[12:13]
    v_pk_fma_f32 v[14:15], v[26:27], v[62:63], v[14:15]
    v_and_or_b32 v12, v12, v93, s76
    v_and_or_b32 v13, v13, v93, s77
    v_and_or_b32 v14, v14, v93, s78
    v_and_or_b32 v15, v15, v93, s79
    s_cmp_eq_u32 s54, 0
    s_cbranch_scc1 L_publ
    global_store_dwordx4 v85, v[12:15], s[30:31] sc1
    s_branch L_pubd
L_publ:
    global_store_dwordx4 v85, v[12:15], s[30:31]
L_pubd:
L_pubret:
    s_barrier
    s_setpc_b64 s[66:67]
L_sv4:
L_down:
L_nodown:
    s_cmp_eq_u32 s3, 4
    s_cbranch_scc1 L_stats
    s_sub_u32 s50, s3, 5
    s_cmp_eq_u32 s61, 1
    s_cbranch_scc0 L_now1
    s_mov_b32 s40, s16
    s_mov_b32 s41, s17
    s_mov_b32 s42, 4194304
    s_mov_b32 s43, 0x20000
    v_lshrrev_b32 v5, 5, v1
    v_lshlrev_b32 v5, 13, v5
    v_bfe_u32 v6, v1, 3, 2
    v_lshl_add_u32 v5, v6, 10, v5
    v_and_b32 v7, 7, v1
    v_lshl_add_u32 v5, v7, 4, v5
    s_lshl_b32 s54, s4, 19
    s_and_b32 s55, s62, 7
    s_lshl_b32 s55, s55, 7
    s_add_u32 s54, s54, s55
    s_and_b32 s55, s62, 8
    s_lshl_b32 s55, s55, 9
    s_add_u32 s54, s54, s55
    s_lshl_b32 s55, s50, 14
    s_add_u32 s54, s54, s55
    s_lshl_b32 s53, s50, 10
L_dma1:
    s_mov_b32 m0, s53
    s_waitcnt vmcnt(3)
    buffer_load_dwordx4 v5, s[40:43], s54 offen nt lds
    s_add_u32 s54, s54, 49152
    s_add_u32 s53, s53, 3072
    s_cmp_lt_u32 s53, 32768
    s_cbranch_scc1 L_dma1
    s_branch L_wdone
L_now1:
    s_cmp_eq_u32 s61, 2
    s_cbranch_scc0 L_wdone
    s_cmp_lt_u32 s50, 3
    s_cbranch_scc0 L_wdone
    v_lshrrev_b32 v5, 4, v1
    v_bfe_u32 v6, v1, 3, 1
    v_lshl_add_u32 v5, v6, 2, v5
    s_lshl_b32 s54, s50, 6
    v_add_u32 v5, s54, v5
    v_mul_u32_u24 v5, 3584, v5
    v_and_b32 v6, 3, v1
    v_lshlrev_b32 v6, 4, v6
    s_lshl_b32 s54, s62, 6
    v_add3_u32 v5, v5, v6, s54
    v_and_b32 v6, 4, v1
    v_cmp_eq_u32 vcc, 0, v6
    v_mov_b32 v6, s22
    v_mov_b32 v4, s20
    v_cndmask_b32 v6, v6, v4, vcc
    v_mov_b32 v7, s23
    v_mov_b32 v4, s21
    v_cndmask_b32 v7, v7, v4, vcc
    v_add_co_u32 v6, vcc, v6, v5
    s_nop 1
    v_addc_co_u32 v7, vcc, 0, v7, vcc
L_dma2:
    s_mul_i32 s53, s50, 8192
    s_add_u32 m0, s53, 0
    s_waitcnt vmcnt(0)
    global_load_lds_dwordx4 v[6:7], off nt
    v_add_co_u32 v6, vcc, 28672, v6
    s_nop 1
    v_addc_co_u32 v7, vcc, 0, v7, vcc
    s_add_u32 m0, s53, 1024
    s_waitcnt vmcnt(0)
    global_load_lds_dwordx4 v[6:7], off nt
    v_add_co_u32 v6, vcc, 28672, v6
    s_nop 1
    v_addc_co_u32 v7, vcc, 0, v7, vcc
    s_add_u32 m0, s53, 2048
    s_waitcnt vmcnt(0)
    global_load_lds_dwordx4 v[6:7], off nt
    v_add_co_u32 v6, vcc, 28672, v6
    s_nop 1
    v_addc_co_u32 v7, vcc, 0, v7, vcc
    s_add_u32 m0, s53, 3072
    s_waitcnt vmcnt(0)
    global_load_lds_dwordx4 v[6:7], off nt
    v_add_co_u32 v6, vcc, 28672, v6
    s_nop 1
    v_addc_co_u32 v7, vcc, 0, v7, vcc
    s_add_u32 m0, s53, 4096
    s_waitcnt vmcnt(0)
    global_load_lds_dwordx4 v[6:7], off nt
    v_add_co_u32 v6, vcc, 28672, v6
    s_nop 1
    v_addc_co_u32 v7, vcc, 0, v7, vcc
    s_add_u32 m0, s53, 5120
    s_waitcnt vmcnt(0)
    global_load_lds_dwordx4 v[6:7], off nt
    v_add_co_u32 v6, vcc, 28672, v6
    s_nop 1
    v_addc_co_u32 v7, vcc, 0, v7, vcc
    s_add_u32 m0, s53, 6144
    s_waitcnt vmcnt(0)
    global_load_lds_dwordx4 v[6:7], off nt
    v_add_co_u32 v6, vcc, 28672, v6
    s_nop 1
    v_addc_co_u32 v7, vcc, 0, v7, vcc
    s_add_u32 m0, s53, 7168
    s_waitcnt vmcnt(0)
    global_load_lds_dwordx4 v[6:7], off nt
    v_add_co_u32 v6, vcc, 487424, v6
    s_nop 1
    v_addc_co_u32 v7, vcc, 0, v7, vcc
    s_add_u32 s50, s50, 3
    s_cmp_lt_u32 s50, 3
    s_cbranch_scc1 L_dma2
L_wdone:
    s_waitcnt vmcnt(0)
    v_mov_b32 v84, 79084
    v_mov_b32 v85, 1
    s_mov_b64 exec, 1
    ds_add_u32 v84, v85
    s_mov_b64 exec, -1
L_svc2:
    v_mov_b32 v84, 79084
L_dw:
    ds_read_b32 v85, v84
    s_sub_u32 s64, s64, 1
    s_cbranch_scc1 L_end
    s_waitcnt lgkmcnt(0)
    v_readfirstlane_b32 s52, v85
    s_nop 0
    s_cmp_ge_u32 s52, 3
    s_cbranch_scc1 L_dw_go
    s_sleep 16
    s_branch L_dw
L_dw_go:
    v_mov_b32 v84, 79080
L_sq:
    ds_read_b32 v85, v84
    s_sub_u32 s64, s64, 1
    s_cbranch_scc1 L_end
    s_waitcnt lgkmcnt(0)
    v_readfirstlane_b32 s52, v85
    s_nop 0
    s_cmp_ge_u32 s52, 1
    s_cbranch_scc1 L_sq_go
    s_sleep 16
    s_branch L_sq
L_sq_go:
    s_cmp_eq_u32 s61, 1
    s_cbranch_scc1 L_st1
    s_cmp_eq_u32 s61, 2
    s_cbranch_scc1 L_st2
    s_cmp_eq_u32 s61, 3
    s_cbranch_scc0 L_svc3
    s_cmp_ge_u32 s3, 6
    s_cbranch_scc1 L_st3
L_svc3:
    v_mov_b32 v84, 79088
    ds_read_b32 v84, v84
    v_mov_b32 v93, 0xffffff00
    s_waitcnt lgkmcnt(0)
    v_readfirstlane_b32 s60, v84
    s_nop 0
    s_bfe_u32 s76, s60, 0x80000
    s_bfe_u32 s77, s60, 0x80008
    s_bfe_u32 s78, s60, 0x80010
    s_bfe_u32 s79, s60, 0x80018
    s_call_b64 s[66:67], L_publish
    s_branch L_fin
L_stats:
    v_mov_b32 v24, 79072
    s_getreg_b32 s71, hwreg(HW_REG_XCC_ID, 0, 4)
    v_mov_b32 v84, 79092
L_ca:
    ds_read_b32 v85, v84
    s_sub_u32 s64, s64, 1
    s_cbranch_scc1 L_end
    s_waitcnt lgkmcnt(0)
    v_readfirstlane_b32 s52, v85
    s_nop 0
    s_cmp_ge_u32 s52, 4
    s_cbranch_scc1 L_ca_go
    s_sleep 4
    s_branch L_ca
L_ca_go:
    s_memrealtime s[68:69]
    s_lshl_b32 s52, s49, 3
    s_add_u32 s52, s52, 49152
    v_mov_b32 v5, s52
    v_mov_b32 v33, s60
    s_waitcnt lgkmcnt(0)
    s_lshl_b32 s68, s68, 4
    s_or_b32 s68, s68, s71
    v_mov_b32 v32, s68
    s_mov_b64 exec, 1
    global_store_dwordx2 v5, v[32:33], s[30:31] sc1
    s_mov_b64 exec, -1
    v_mov_b32 v84, 79092
L_ga:
    ds_read_b32 v85, v84
    s_sub_u32 s64, s64, 1
    s_cbranch_scc1 L_end
    s_waitcnt lgkmcnt(0)
    v_readfirstlane_b32 s52, v85
    s_nop 0
    s_cmp_ge_u32 s52, 5
    s_cbranch_scc1 L_ga_go
    s_sleep 8
    s_branch L_ga
L_ga_go:
    v_lshlrev_b32 v6, 5, v1
    v_add_u32 v6, 49152, v6
    global_load_dwordx4 v[32:35], v6, s[30:31] sc1
    global_load_dwordx4 v[36:39], v6, s[30:31] offset:16 sc1
    s_waitcnt vmcnt(0)
    v_or3_b32 v41, v32, v34, v36
    v_or_b32 v41, v41, v38
    v_and_b32 v42, v32, v34
    v_and_b32 v43, v36, v38
    v_and_b32 v42, v42, v43
    v_xor_b32 v41, s71, v41
    v_bitop3_b32 v41, v41, v42, s71 bitop3:0xf6
    v_and_b32 v41, 15, v41
    v_bitop3_b32 v41, v41, v33, s60 bitop3:0xf6
    v_bitop3_b32 v41, v41, v35, s60 bitop3:0xf6
    v_bitop3_b32 v41, v41, v37, s60 bitop3:0xf6
    v_bitop3_b32 v41, v41, v39, s60 bitop3:0xf6
    v_cmp_ne_u32 vcc, 0, v41
    s_lshl_b32 s52, s4, 3
    s_lshr_b64 vcc, vcc, s52
    s_and_b32 s70, vcc_lo, 0xff
    v_mov_b32 v41, s70
    ds_write_b32 v24, v41 offset:40
    v_mov_b32 v40, -6400
    v_sub_u32 v32, s68, v32
    v_cmp_eq_u32 vcc, s60, v33
    s_nop 1
    v_cndmask_b32 v32, v40, v32, vcc
    v_sub_u32 v34, s68, v34
    v_cmp_eq_u32 vcc, s60, v35
    s_nop 1
    v_cndmask_b32 v34, v40, v34, vcc
    v_sub_u32 v36, s68, v36
    v_cmp_eq_u32 vcc, s60, v37
    s_nop 1
    v_cndmask_b32 v36, v40, v36, vcc
    v_sub_u32 v38, s68, v38
    v_cmp_eq_u32 vcc, s60, v39
    s_nop 1
    v_cndmask_b32 v38, v40, v38, vcc
    v_add3_u32 v32, v32, v34, v36
    v_add_u32 v32, v32, v38
    v_cvt_f32_i32 v32, v32
    s_nop 1
    v_add_f32_dpp v32, v32, v32 quad_perm:[1,0,3,2] row_mask:0xf bank_mask:0xf
    s_nop 1
    v_add_f32_dpp v32, v32, v32 quad_perm:[2,3,0,1] row_mask:0xf bank_mask:0xf
    s_nop 1
    v_add_f32_dpp v32, v32, v32 row_ror:8 row_mask:0xf bank_mask:0xf
    s_nop 1
    v_add_f32_dpp v32, v32, v32 row_ror:4 row_mask:0xf bank_mask:0xf
    v_mov_b32 v33, v32
    s_nop 1
    v_permlane16_swap_b32 v33, v32
    v_add_f32 v32, v33, v32
    v_mov_b32 v33, v32
    s_nop 1
    v_permlane32_swap_b32 v33, v32
    v_add_f32 v32, v33, v32
    v_mov_b32 v19, 0.0
    v_fmac_f32 v19, 0x39800000, v32
    v_mov_b32 v28, 130.0
    v_fmac_f32 v28, 0.32, v19
    v_mov_b32 v29, 130.0
    v_fmac_f32 v29, -0.25, v19
    v_cmp_lt_f32 vcc, 0, v19
    s_nop 1
    v_cndmask_b32 v28, 0, v28, vcc
    v_cndmask_b32 v29, v29, 0, vcc
    v_cvt_i32_f32 v26, v28
    v_cvt_i32_f32 v27, v29
    ds_write_b64 v24, v[26:27] offset:24
    v_subrev_f32 v30, 152.0, v28
    v_mov_b32 v31, 38.0
    v_med3_f32 v30, v30, 0, v31
    v_mov_b32 v84, 79076
L_sw:
    ds_read_b32 v85, v84
    s_sub_u32 s64, s64, 1
    s_cbranch_scc1 L_end
    s_waitcnt lgkmcnt(0)
    v_readfirstlane_b32 s52, v85
    s_nop 0
    s_cmp_ge_u32 s52, 4
    s_cbranch_scc1 L_sw_go
    s_sleep 4
    s_branch L_sw
L_sw_go:
    v_and_b32 v86, 3, v1
    v_lshlrev_b32 v84, 3, v86
    v_add_u32 v84, 78912, v84
    ds_read_b64 v[12:13], v84 offset:0
    ds_read_b64 v[14:15], v84 offset:32
    ds_read_b64 v[16:17], v84 offset:64
    ds_read_b64 v[18:19], v84 offset:96
    s_waitcnt lgkmcnt(0)
    v_max3_f32 v20, v12, v14, v16
    v_max_f32 v20, v20, v18
    v_sub_f32 v12, v12, v20
    v_sub_f32 v14, v14, v20
    v_sub_f32 v16, v16, v20
    v_sub_f32 v18, v18, v20
    v_exp_f32 v12, v12
    v_exp_f32 v14, v14
    v_exp_f32 v16, v16
    v_exp_f32 v18, v18
    v_mul_f32 v22, v12, v13
    v_fmac_f32 v22, v14, v15
    v_fmac_f32 v22, v16, v17
    v_fmac_f32 v22, v18, v19
    v_mov_b32 v21, s60
    v_mov_b32 v23, s60
    s_lshl_b32 s52, s49, 6
    s_add_u32 s52, s52, 32768
    v_add_u32 v5, s52, v3
    s_mov_b64 exec, 0xf
    s_cmp_eq_u32 s70, 0
    s_cbranch_scc1 L_stl
    global_store_dwordx4 v5, v[20:23], s[30:31] sc1
    s_branch L_std
L_stl:
    global_store_dwordx4 v5, v[20:23], s[30:31]
L_std:
    s_mov_b64 exec, -1
    v_mov_b32 v84, 79092
L_cb:
    ds_read_b32 v85, v84
    s_sub_u32 s64, s64, 1
    s_cbranch_scc1 L_end
    s_waitcnt lgkmcnt(0)
    v_readfirstlane_b32 s52, v85
    s_nop 0
    s_cmp_ge_u32 s52, 12
    s_cbranch_scc1 L_cb_go
    s_sleep 4
    s_branch L_cb
L_cb_go:
    s_memrealtime s[68:69]
    s_lshl_b32 s52, s49, 3
    s_add_u32 s52, s52, 51200
    v_mov_b32 v5, s52
    v_mov_b32 v33, s60
    s_waitcnt lgkmcnt(0)
    s_lshl_b32 s68, s68, 4
    s_or_b32 s68, s68, s71
    v_mov_b32 v32, s68
    s_mov_b64 exec, 1
    global_store_dwordx2 v5, v[32:33], s[30:31] sc1
    s_mov_b64 exec, -1
    s_lshl_b32 s52, s4, 11
    s_add_u32 s52, s52, 32768
    v_add_u32 v5, s52, v3
    v_mov_b32 v84, 79092
L_sg:
    ds_read_b32 v85, v84
    s_sub_u32 s64, s64, 1
    s_cbranch_scc1 L_end
    s_waitcnt lgkmcnt(0)
    v_readfirstlane_b32 s52, v85
    s_nop 0
    s_cmp_ge_u32 s52, 13
    s_cbranch_scc1 L_sg_go
    s_sleep 8
    s_branch L_sg
L_sg_go:
    v_lshlrev_b32 v6, 5, v1
    v_add_u32 v6, 51200, v6
    global_load_dwordx4 v[32:35], v6, s[30:31] sc1
    global_load_dwordx4 v[36:39], v6, s[30:31] offset:16 sc1
    v_and_b32 v44, 31, v1
    v_lshlrev_b32 v44, 3, v44
    s_lshl_b32 s52, s4, 8
    s_add_u32 s52, s52, 53248
    v_add_u32 v44, s52, v44
    global_load_dwordx2 v[46:47], v44, s[30:31] offset:0 sc1
    s_waitcnt vmcnt(0)
    v_mov_b32 v40, -6400
    v_sub_u32 v32, s68, v32
    v_cmp_eq_u32 vcc, s60, v33
    s_nop 1
    v_cndmask_b32 v32, v40, v32, vcc
    v_sub_u32 v34, s68, v34
    v_cmp_eq_u32 vcc, s60, v35
    s_nop 1
    v_cndmask_b32 v34, v40, v34, vcc
    v_sub_u32 v36, s68, v36
    v_cmp_eq_u32 vcc, s60, v37
    s_nop 1
    v_cndmask_b32 v36, v40, v36, vcc
    v_sub_u32 v38, s68, v38
    v_cmp_eq_u32 vcc, s60, v39
    s_nop 1
    v_cndmask_b32 v38, v40, v38, vcc
    v_add3_u32 v32, v32, v34, v36
    v_add_u32 v32, v32, v38
    v_cvt_f32_i32 v32, v32
    s_nop 1
    v_add_f32_dpp v32, v32, v32 quad_perm:[1,0,3,2] row_mask:0xf bank_mask:0xf
    s_nop 1
    v_add_f32_dpp v32, v32, v32 quad_perm:[2,3,0,1] row_mask:0xf bank_mask:0xf
    s_nop 1
    v_add_f32_dpp v32, v32, v32 row_ror:8 row_mask:0xf bank_mask:0xf
    s_nop 1
    v_add_f32_dpp v32, v32, v32 row_ror:4 row_mask:0xf bank_mask:0xf
    v_mov_b32 v33, v32
    s_nop 1
    v_permlane16_swap_b32 v33, v32
    v_add_f32 v32, v33, v32
    v_mov_b32 v33, v32
    s_nop 1
    v_permlane32_swap_b32 v33, v32
    v_add_f32 v32, v33, v32
    v_mov_b32 v19, 20.0
    v_fmac_f32 v19, 0x39800000, v32
    s_cmp_eq_u32 s61, 2
    s_cselect_b32 s52, 110, 0
    s_cmp_eq_u32 s61, 1
    s_cselect_b32 s52, 0, s52
    v_cvt_f32_i32 v25, s52
    v_add_f32 v19, v19, v25
    v_mov_b32 v28, 190.0
    v_sub_f32 v28, v28, v30
    v_fmac_f32 v28, 0.32, v19
    v_mov_b32 v29, 190.0
    v_fmac_f32 v29, -0.25, v19
    v_cmp_lt_f32 vcc, 0, v19
    s_nop 1
    v_cndmask_b32 v28, 0, v28, vcc
    v_cndmask_b32 v29, v29, 0, vcc
    v_cvt_i32_f32 v26, v28
    v_cvt_i32_f32 v27, v29
    ds_write_b64 v24, v[26:27] offset:24
L_spoll:
    s_sub_u32 s64, s64, 1
    s_cbranch_scc1 L_end
    global_load_dwordx4 v[12:15], v5, s[30:31] sc1
    global_load_dwordx4 v[16:19], v5, s[30:31] offset:1024 sc1
    s_waitcnt vmcnt(0)
    v_xor_b32 v13, s60, v13
    v_bitop3_b32 v13, v13, v15, s60 bitop3:0xf6
    v_bitop3_b32 v13, v13, v17, s60 bitop3:0xf6
    v_bitop3_b32 v13, v13, v19, s60 bitop3:0xf6
    v_cmp_ne_u32 vcc, 0, v13
    s_cbranch_vccz L_sgot
    s_sleep 32
    s_branch L_spoll
L_sgot:
    v_max_f32 v20, v12, v16
    s_nop 1
    v_max_f32_dpp v20, v20, v20 row_ror:8 row_mask:0xf bank_mask:0xf
    s_nop 1
    v_max_f32_dpp v20, v20, v20 row_ror:4 row_mask:0xf bank_mask:0xf
    v_mov_b32 v21, v20
    s_nop 1
    v_permlane16_swap_b32 v21, v20
    v_max_f32 v20, v21, v20
    v_mov_b32 v21, v20
    s_nop 1
    v_permlane32_swap_b32 v21, v20
    v_max_f32 v20, v21, v20
    v_sub_f32 v12, v12, v20
    v_sub_f32 v16, v16, v20
    v_exp_f32 v12, v12
    v_exp_f32 v16, v16
    v_mul_f32 v21, v12, v14
    v_fmac_f32 v21, v16, v18
    s_nop 1
    v_add_f32_dpp v21, v21, v21 row_ror:8 row_mask:0xf bank_mask:0xf
    s_nop 1
    v_add_f32_dpp v21, v21, v21 row_ror:4 row_mask:0xf bank_mask:0xf
    v_mov_b32 v22, v21
    s_nop 1
    v_permlane16_swap_b32 v22, v21
    v_add_f32 v21, v22, v21
    v_mov_b32 v22, v21
    s_nop 1
    v_permlane32_swap_b32 v22, v21
    v_add_f32 v21, v22, v21
    v_rcp_f32 v21, v21
    v_lshlrev_b32 v84, 3, v86
    v_add_u32 v84, 79040, v84
    ds_write_b64 v84, v[20:21]
    v_mov_b32 v84, 79080
    v_mov_b32 v85, 1
    ds_write_b32 v84, v85
    s_cmp_eq_u32 s70, 0
    s_cbranch_scc0 L_svc2
    s_lshl_b32 s52, s49, 3
    s_add_u32 s52, s52, 53248
    v_mov_b32 v45, s52
    v_mov_b32 v84, 79092
L_lc0:
    ds_read_b32 v85, v84
    s_sub_u32 s64, s64, 1
    s_cbranch_scc1 L_end
    s_waitcnt lgkmcnt(0)
    v_readfirstlane_b32 s52, v85
    s_nop 0
    s_cmp_ge_u32 s52, 20
    s_cbranch_scc1 L_lc0_go
    s_sleep 2
    s_branch L_lc0
L_lc0_go:
    s_memrealtime s[68:69]
    v_mov_b32 v33, s60
    v_subrev_f32 v30, 206.0, v28
    v_mov_b32 v31, 12.0
    v_med3_f32 v30, v30, 0, v31
    s_waitcnt lgkmcnt(0)
    v_mov_b32 v32, s68
    s_mov_b64 exec, 1
    global_store_dwordx2 v45, v[32:33], s[30:31] offset:0
    s_mov_b64 exec, -1
    v_mov_b32 v84, 79092
L_lg0:
    ds_read_b32 v85, v84
    s_sub_u32 s64, s64, 1
    s_cbranch_scc1 L_end
    s_waitcnt lgkmcnt(0)
    v_readfirstlane_b32 s52, v85
    s_nop 0
    s_cmp_ge_u32 s52, 21
    s_cbranch_scc1 L_lg0_go
    s_sleep 2
    s_branch L_lg0
L_lg0_go:
    global_load_dwordx2 v[32:33], v44, s[30:31] offset:0 sc1
    v_mov_b32 v40, -111
    s_waitcnt vmcnt(0)
    v_sub_u32 v32, s68, v32
    v_cmp_eq_u32 vcc, s60, v33
    s_nop 1
    v_cndmask_b32 v32, v40, v32, vcc
    v_cvt_f32_i32 v32, v32
    s_nop 1
    v_add_f32_dpp v32, v32, v32 quad_perm:[1,0,3,2] row_mask:0xf bank_mask:0xf
    s_nop 1
    v_add_f32_dpp v32, v32, v32 quad_perm:[2,3,0,1] row_mask:0xf bank_mask:0xf
    s_nop 1
    v_add_f32_dpp v32, v32, v32 row_ror:8 row_mask:0xf bank_mask:0xf
    s_nop 1
    v_add_f32_dpp v32, v32, v32 row_ror:4 row_mask:0xf bank_mask:0xf
    v_mov_b32 v33, v32
    s_nop 1
    v_permlane16_swap_b32 v33, v32
    v_add_f32 v32, v33, v32
    v_mov_b32 v33, v32
    s_nop 1
    v_permlane32_swap_b32 v33, v32
    v_add_f32 v32, v33, v32
    v_add_f32 v19, 0.0, v25
    v_fmac_f32 v19, 0x3c800000, v32
    v_mov_b32 v28, 218.0
    v_sub_f32 v28, v28, v30
    v_fmac_f32 v28, 0.26, v19
    v_mov_b32 v29, 218.0
    v_fmac_f32 v29, -0.3, v19
    v_cmp_lt_f32 vcc, 0, v19
    s_nop 1
    v_cndmask_b32 v28, 0, v28, vcc
    v_cndmask_b32 v29, v29, 0, vcc
    v_cvt_i32_f32 v26, v28
    v_cvt_i32_f32 v27, v29
    ds_write_b64 v24, v[26:27] offset:24
    s_branch L_svc2
.section .rodata,"a"
.p2align 6
.amdhsa_kernel sequential_preLN__gqa_block_cached__glu_gated_bilinear__decode_kernel
  .amdhsa_next_free_vgpr 256
  .amdhsa_next_free_sgpr 102
  .amdhsa_accum_offset 256
  .amdhsa_group_segment_fixed_size 0
  .amdhsa_kernarg_size 96
  .amdhsa_user_sgpr_count 2
  .amdhsa_user_sgpr_kernarg_segment_ptr 1
  .amdhsa_system_sgpr_workgroup_id_x 1
  .amdhsa_float_denorm_mode_32 3
.end_amdhsa_kernel
```
